```python
import torch

def _softmax(x, axis=-1):
    return torch.softmax(x, dim=axis)
def _gelu(x):
    return torch.nn.functional.gelu(x, approximate="tanh")
def _silu(x):
    return torch.nn.functional.silu(x)
def _sigmoid(x):
    return torch.sigmoid(x)
def _layernorm(x, axis=-1, eps=1e-5):
    m = x.mean(dim=axis, keepdim=True)
    v = x.var(dim=axis, keepdim=True, unbiased=False)
    return (x - m) / torch.sqrt(v + eps)
def _scatter_add(tgt, idx, src, axis=0):
    return tgt.clone().index_add_(axis, idx, src)
def _segment_sum(src, seg, n):
    out = torch.zeros((n,) + src.shape[1:], dtype=src.dtype)
    return out.index_add_(0, seg, src)
def _pad(x, pw):
    flat = tuple(v for pair in reversed(pw) for v in pair)
    return torch.nn.functional.pad(x, flat)

kernel_name = 'concat_heads__gqa_block_cached__gqa_block_cached__near_ridge'

def setup_inputs():

    _w = (lambda a: (lambda t: t.to(torch.bfloat16) if t.is_floating_point() else t)(torch.as_tensor(a)))
    def _A_setup():
        B, Sq, D = 16, 32, 512
        Hq, Hkv, Sk, Dh = 32, 8, 1024, 128
        assert Hq % Hkv == 0, (Hq, Hkv)
        return {
            "x": _w((lambda *s: torch.randn(*s, dtype=torch.bfloat16) * 0.8)(B, Sq, D)),
            "k_cache": _w((lambda *s: torch.randn(*s, dtype=torch.bfloat16) * 0.8)(B, Hkv, Sk, Dh)),
            "v_cache": _w((lambda *s: torch.randn(*s, dtype=torch.bfloat16) * 0.05)(B, Hkv, Sk, Dh)),
            "wq": _w((lambda *s: torch.randn(*s, dtype=torch.bfloat16) * 0.8)(D, Hq * Dh) * (D ** -0.5)),
            "wo": _w((lambda *s: torch.randn(*s, dtype=torch.bfloat16) * 0.05)(Hq * Dh, D) * ((Hq * Dh) ** -0.5)),
        }
    _A_in = _A_setup()

    def _B_setup():
        B, Sq, D = 16, 32, 512
        Hq, Hkv, Sk, Dh = 32, 8, 1024, 128
        assert Hq % Hkv == 0, (Hq, Hkv)
        return {
            "x": _w((lambda *s: torch.randn(*s, dtype=torch.bfloat16) * 0.8)(B, Sq, D)),
            "k_cache": _w((lambda *s: torch.randn(*s, dtype=torch.bfloat16) * 0.8)(B, Hkv, Sk, Dh)),
            "v_cache": _w((lambda *s: torch.randn(*s, dtype=torch.bfloat16) * 0.05)(B, Hkv, Sk, Dh)),
            "wq": _w((lambda *s: torch.randn(*s, dtype=torch.bfloat16) * 0.8)(D, Hq * Dh) * (D ** -0.5)),
            "wo": _w((lambda *s: torch.randn(*s, dtype=torch.bfloat16) * 0.05)(Hq * Dh, D) * ((Hq * Dh) ** -0.5)),
        }
    _B_in = _B_setup()

    return {
        "A_x": _A_in["x"],
        "A_k_cache": _A_in["k_cache"],
        "A_v_cache": _A_in["v_cache"],
        "A_wq": _A_in["wq"],
        "A_wo": _A_in["wo"],
        "B_x": _B_in["x"],
        "B_k_cache": _B_in["k_cache"],
        "B_v_cache": _B_in["v_cache"],
        "B_wq": _B_in["wq"],
        "B_wo": _B_in["wo"],
    }

def reference(A_x, A_k_cache, A_v_cache, A_wq, A_wo, B_x, B_k_cache, B_v_cache, B_wq, B_wo):
    def _A_ref(x, k_cache, v_cache, wq, wo):
        B, Sq, D = x.shape
        Hq, Dh = 32, 128
        Hkv = k_cache.shape[1]
        rep = Hq // Hkv
        q = (lambda x, *d: x.permute(*d))((x @ wq).reshape(B, Sq, Hq, Dh), 0, 2, 1, 3)
        k = (lambda x, n, axis: torch.repeat_interleave(x, n, dim=axis))(k_cache, rep, axis=1)
        v = (lambda x, n, axis: torch.repeat_interleave(x, n, dim=axis))(v_cache, rep, axis=1)
        scores = torch.einsum("bhqd,bhkd->bhqk", q, k) * (Dh ** -0.5)
        p = _softmax(scores, axis=-1)
        o = torch.einsum("bhqk,bhkd->bhqd", p, v)
        return (lambda x, *d: x.permute(*d))(o, 0, 2, 1, 3).reshape(B, Sq, Hq * Dh) @ wo

    def _B_ref(x, k_cache, v_cache, wq, wo):
        B, Sq, D = x.shape
        Hq, Dh = 32, 128
        Hkv = k_cache.shape[1]
        rep = Hq // Hkv
        q = (lambda x, *d: x.permute(*d))((x @ wq).reshape(B, Sq, Hq, Dh), 0, 2, 1, 3)
        k = (lambda x, n, axis: torch.repeat_interleave(x, n, dim=axis))(k_cache, rep, axis=1)
        v = (lambda x, n, axis: torch.repeat_interleave(x, n, dim=axis))(v_cache, rep, axis=1)
        scores = torch.einsum("bhqd,bhkd->bhqk", q, k) * (Dh ** -0.5)
        p = _softmax(scores, axis=-1)
        o = torch.einsum("bhqk,bhkd->bhqd", p, v)
        return (lambda x, *d: x.permute(*d))(o, 0, 2, 1, 3).reshape(B, Sq, Hq * Dh) @ wo

    a = _A_ref(A_x, A_k_cache, A_v_cache, A_wq, A_wo)
    b = _B_ref(B_x, B_k_cache, B_v_cache, B_wq, B_wo)
    return torch.concatenate([a, b], axis=-1)
```

```asm
; @launch grid=(256,1,1) block=(512,1,1) lds=163840
.amdgcn_target "amdgcn-amd-amdhsa--gfx950"
.text
.globl concat_heads__gqa_block_cached__gqa_block_cached__near_ridge_kernel
.p2align 8
.type concat_heads__gqa_block_cached__gqa_block_cached__near_ridge_kernel,@function
concat_heads__gqa_block_cached__gqa_block_cached__near_ridge_kernel:
L_start:
    s_cmp_ge_u32 s2, 256
    s_cbranch_scc1 L_end
    s_load_dwordx16 s[4:19], s[0:1], 0
    s_load_dwordx8 s[20:27], s[0:1], 64
    s_load_dwordx2 s[28:29], s[0:1], 96
    v_lshrrev_b32 v1, 6, v0
    v_and_b32 v0, 63, v0
    v_readfirstlane_b32 s30, v1
    s_and_b32 s31, s2, 3
    s_lshl_b32 s31, s31, 1
    s_bfe_u32 s32, s2, 0x10003
    s_add_u32 s31, s31, s32
    s_bfe_u32 s32, s2, 0x10002
    s_lshr_b32 s33, s2, 4
    s_lshl_b32 s34, s32, 4
    s_add_u32 s34, s34, s33
    s_lshl_b32 s35, s33, 1
    s_and_b32 s79, s31, 1
    v_lshrrev_b32 v1, 4, v0
    v_and_b32 v2, 15, v0
    v_lshrrev_b32 v3, 5, v0
    v_lshlrev_b32 v4, 4, v0
    s_lshl_b32 s68, s33, 3
    s_add_u32 s68, s68, s31
    s_lshl_b32 s68, s68, 18
    s_lshl_b32 s69, s33, 15
    s_lshl_b32 s70, s31, 10
    s_mov_b32 s38, 262144
    s_mov_b32 s39, 0x20000
    s_mov_b32 s42, 262144
    s_mov_b32 s43, 0x20000
    s_mov_b32 s46, 32768
    s_mov_b32 s47, 0x20000
    s_sub_u32 s50, 0x400000, s70
    s_mov_b32 s51, 0x20000
    s_mov_b32 s54, 524288
    s_mov_b32 s55, 0x20000
    s_mov_b32 s58, 16809984
    s_mov_b32 s59, 0x20000
    s_mov_b32 s63, 0x20000
    s_mov_b32 s66, 256
    s_mov_b32 s67, 0x20000
    s_lshl_b32 s84, s30, 11
    s_lshl_b32 s85, s30, 7
    s_lshl_b32 s87, s35, 14
    s_add_u32 s87, s87, s85
    s_waitcnt lgkmcnt(0)
    s_cmp_eq_u32 s32, 0
    s_cselect_b32 s36, s6, s16
    s_cselect_b32 s37, s7, s17
    s_cselect_b32 s40, s8, s18
    s_cselect_b32 s41, s9, s19
    s_cselect_b32 s44, s4, s14
    s_cselect_b32 s45, s5, s15
    s_cselect_b32 s48, s10, s20
    s_cselect_b32 s49, s11, s21
    s_cselect_b32 s52, s12, s22
    s_cselect_b32 s53, s13, s23
    s_add_u32 s36, s36, s68
    s_addc_u32 s37, s37, 0
    s_add_u32 s40, s40, s68
    s_addc_u32 s41, s41, 0
    s_add_u32 s44, s44, s69
    s_addc_u32 s45, s45, 0
    s_add_u32 s48, s48, s70
    s_addc_u32 s49, s49, 0
    s_lshl_b32 s68, s31, 19
    s_add_u32 s52, s52, s68
    s_addc_u32 s53, s53, 0
    s_mov_b32 s56, s28
    s_mov_b32 s57, s29
    s_lshl_b32 s68, s32, 10
    s_lshl_b32 s69, s31, 7
    s_add_u32 s68, s68, s69
    s_sub_u32 s62, 65536, s68
    s_lshl_b32 s69, s33, 16
    s_add_u32 s68, s68, s69
    s_add_u32 s60, s24, s68
    s_addc_u32 s61, s25, 0
    s_mov_b32 s64, s26
    s_mov_b32 s65, s27
    s_cmp_lt_u32 s30, 4
    s_cbranch_scc1 L_compute
    s_setprio 1
    s_sub_u32 s76, s30, 4
    s_and_b32 s68, s76, 1
    s_lshl_b32 s68, s68, 2
    s_xor_b32 s68, s68, s35
    s_lshl_b32 s68, s68, 5
    v_xor_b32 v16, s68, v4
    s_lshl_b32 s69, s76, 13
    s_add_u32 m0, s69, 65536
    v_xor_b32 v17, 16, v16
    buffer_load_dwordx4 v16, s[44:47], s69 offen offset:0 lds
    v_xor_b32 v18, 32, v16
    buffer_load_dwordx4 v17, s[44:47], s69 offen offset:1024 lds
    v_xor_b32 v19, 48, v16
    buffer_load_dwordx4 v18, s[44:47], s69 offen offset:2048 lds
    v_xor_b32 v20, 64, v16
    buffer_load_dwordx4 v19, s[44:47], s69 offen offset:3072 lds
    s_add_u32 m0, s69, 69632
    s_add_u32 s69, s69, 4096
    v_xor_b32 v21, 80, v16
    buffer_load_dwordx4 v20, s[44:47], s69 offen offset:0 lds
    v_xor_b32 v22, 96, v16
    buffer_load_dwordx4 v21, s[44:47], s69 offen offset:1024 lds
    v_xor_b32 v23, 112, v16
    buffer_load_dwordx4 v22, s[44:47], s69 offen offset:2048 lds
    buffer_load_dwordx4 v23, s[44:47], s69 offen offset:3072 lds
    v_xor_b32 v10, v2, v1
    v_lshlrev_b32 v10, 4, v10
    v_lshl_add_u32 v5, v1, 8, v10
    v_xor_b32 v6, 64, v5
    v_xor_b32 v7, 128, v5
    v_xor_b32 v8, 192, v5
    v_lshlrev_b32 v10, 1, v1
    v_xor_b32 v10, v10, v2
    v_lshlrev_b32 v10, 4, v10
    v_lshl_add_u32 v9, v1, 8, v10
    v_xor_b32 v12, 128, v9
    s_lshl_b32 s72, s76, 12
    s_cmp_eq_u32 s79, 0
    s_cbranch_scc1 L_helper
    s_add_u32 m0, s72, 0
    s_add_u32 s68, s72, 0
    buffer_load_dwordx4 v5, s[36:39], s68 offen offset:0 nt lds
    buffer_load_dwordx4 v6, s[36:39], s68 offen offset:1024 nt lds
    buffer_load_dwordx4 v7, s[36:39], s68 offen offset:2048 nt lds
    buffer_load_dwordx4 v8, s[36:39], s68 offen offset:3072 nt lds
    s_add_u32 m0, s72, 16384
    s_add_u32 s68, s72, 0
    buffer_load_dwordx4 v9, s[40:43], s68 offen offset:0 nt lds
    buffer_load_dwordx4 v12, s[40:43], s68 offen offset:1024 nt lds
    buffer_load_dwordx4 v9, s[40:43], s68 offen offset:2048 nt lds
    buffer_load_dwordx4 v12, s[40:43], s68 offen offset:3072 nt lds
    s_branch L_hkv
L_compute:
    v_lshlrev_b32 v9, 2, v1
    v_xor_b32 v9, v9, v2
    v_lshlrev_b32 v9, 4, v9
    v_lshl_add_u32 v9, v1, 13, v9
    s_lshl_b32 s68, s30, 8
    v_add_u32 v5, s68, v9
    v_add_u32 v6, 31744, v5
    v_add_u32 v7, 63488, v5
    v_add_u32 v8, 95232, v5
    s_add_u32 s72, s30, 6
    s_lshl_b32 s72, s72, 14
    s_lshl_b32 s73, s35, 17
    s_lshl_b32 s78, s30, 13
    s_add_u32 s78, s78, 65536
    s_cmp_eq_u32 s79, 0
    s_cbranch_scc0 L_nowq0
    s_add_u32 m0, s72, 0
    s_xor_b32 s68, s73, 0
    buffer_load_dwordx4 v5, s[48:51], s68 offen offset:0 lds
    buffer_load_dwordx4 v6, s[48:51], s68 offen offset:1024 lds
    buffer_load_dwordx4 v7, s[48:51], s68 offen offset:2048 lds
    buffer_load_dwordx4 v8, s[48:51], s68 offen offset:3072 lds
    s_add_u32 m0, s72, 4096
    s_xor_b32 s68, s73, 131072
    buffer_load_dwordx4 v5, s[48:51], s68 offen offset:0 lds
    buffer_load_dwordx4 v6, s[48:51], s68 offen offset:1024 lds
    buffer_load_dwordx4 v7, s[48:51], s68 offen offset:2048 lds
    buffer_load_dwordx4 v8, s[48:51], s68 offen offset:3072 lds
    s_add_u32 m0, s72, 8192
    s_xor_b32 s68, s73, 262144
    buffer_load_dwordx4 v5, s[48:51], s68 offen offset:0 lds
    buffer_load_dwordx4 v6, s[48:51], s68 offen offset:1024 lds
    buffer_load_dwordx4 v7, s[48:51], s68 offen offset:2048 lds
    buffer_load_dwordx4 v8, s[48:51], s68 offen offset:3072 lds
L_nowq0:
    s_cmp_eq_u32 s30, 0
    s_cbranch_scc0 L_noclear
    s_lshl_b32 s68, s34, 3
    s_add_u32 s68, s68, s31
    s_lshl_b32 s68, s68, 7
    s_add_u32 s68, s68, 16777216
    v_mov_b32 v10, 0
    v_lshlrev_b32 v11, 2, v0
    s_mov_b64 exec, 0xff
    buffer_store_dword v10, v11, s[56:59], s68 offen sc1
    s_mov_b64 exec, -1
L_noclear:
    v_bfe_u32 v13, v0, 2, 2
    v_and_b32 v14, 1, v0
    v_bfe_u32 v15, v0, 1, 1
    v_lshlrev_b32 v14, 4, v14
    v_lshl_add_u32 v14, v15, 3, v14
    v_and_b32 v15, 1, v1
    v_lshl_add_u32 v14, v15, 5, v14
    v_lshlrev_b32 v12, 11, v3
    v_mul_u32_u24 v15, 320, v13
    v_add3_u32 v12, v12, v15, v14
    v_add_u32 v16, s72, v12
    v_xor_b32 v17, 64, v16
    v_xor_b32 v18, 128, v16
    v_xor_b32 v19, 192, v16
    v_and_b32 v20, 31, v0
    v_xor_b32 v21, v3, v2
    v_lshlrev_b32 v21, 4, v21
    v_lshl_add_u32 v21, v20, 10, v21
    v_add_u32 v21, 65536, v21
    v_xor_b32 v22, 32, v21
    v_xor_b32 v23, 64, v21
    v_xor_b32 v24, 96, v21
    v_xor_b32 v25, 128, v21
    v_xor_b32 v26, 160, v21
    v_xor_b32 v27, 192, v21
    v_xor_b32 v28, 224, v21
    v_xor_b32 v14, v1, v2
    v_lshlrev_b32 v14, 4, v14
    v_lshl_add_u32 v29, v2, 8, v14
    v_bfe_u32 v14, v0, 2, 4
    v_and_b32 v15, 7, v14
    v_lshlrev_b32 v14, 8, v14
    v_lshl_add_u32 v14, v15, 5, v14
    v_and_b32 v15, 3, v0
    v_lshl_add_u32 v13, v15, 3, v14
    v_lshlrev_b32 v14, 4, v2
    v_lshl_add_u32 v14, v3, 10, v14
    v_and_b32 v15, 1, v1
    v_lshl_add_u32 v9, v15, 9, v14
    v_mov_b32 v30, 0x3e0293ee
    s_mov_b32 s74, 0x41000000
    s_barrier
    ds_read_b128 v[128:131], v21 offset:0
    ds_read_b128 v[132:135], v22 offset:0
    ds_read_b128 v[136:139], v23 offset:0
    ds_read_b128 v[140:143], v24 offset:0
    ds_read_b128 v[144:147], v25 offset:0
    ds_read_b128 v[148:151], v26 offset:0
    ds_read_b128 v[152:155], v27 offset:0
    ds_read_b128 v[156:159], v28 offset:0
    ds_read_b128 v[160:163], v21 offset:256
    ds_read_b128 v[164:167], v22 offset:256
    ds_read_b128 v[168:171], v23 offset:256
    ds_read_b128 v[172:175], v24 offset:256
    ds_read_b128 v[176:179], v25 offset:256
    ds_read_b128 v[180:183], v26 offset:256
    ds_read_b128 v[184:187], v27 offset:256
    s_waitcnt lgkmcnt(7)
    ds_read_b128 v[188:191], v28 offset:256
    ds_read_b128 v[192:195], v21 offset:512
    ds_read_b128 v[196:199], v22 offset:512
    ds_read_b128 v[200:203], v23 offset:512
    ds_read_b128 v[204:207], v24 offset:512
    ds_read_b128 v[208:211], v25 offset:512
    ds_read_b128 v[212:215], v26 offset:512
    ds_read_b128 v[216:219], v27 offset:512
    s_waitcnt lgkmcnt(7)
    ds_read_b128 v[220:223], v28 offset:512
    ds_read_b128 v[224:227], v21 offset:768
    ds_read_b128 v[228:231], v22 offset:768
    ds_read_b128 v[232:235], v23 offset:768
    ds_read_b128 v[236:239], v24 offset:768
    ds_read_b128 v[240:243], v25 offset:768
    ds_read_b128 v[244:247], v26 offset:768
    ds_read_b128 v[248:251], v27 offset:768
    s_waitcnt lgkmcnt(7)
    ds_read_b128 v[252:255], v28 offset:768
    s_waitcnt lgkmcnt(0)
    s_barrier
    s_barrier
    s_cmp_eq_u32 s79, 0
    s_cbranch_scc1 L_wq1
    s_add_u32 m0, s72, 0
    s_xor_b32 s68, s73, 0
    buffer_load_dwordx4 v5, s[48:51], s68 offen offset:0 lds
    buffer_load_dwordx4 v6, s[48:51], s68 offen offset:1024 lds
    buffer_load_dwordx4 v7, s[48:51], s68 offen offset:2048 lds
    buffer_load_dwordx4 v8, s[48:51], s68 offen offset:3072 lds
    s_add_u32 m0, s72, 4096
    s_xor_b32 s68, s73, 131072
    buffer_load_dwordx4 v5, s[48:51], s68 offen offset:0 lds
    buffer_load_dwordx4 v6, s[48:51], s68 offen offset:1024 lds
    buffer_load_dwordx4 v7, s[48:51], s68 offen offset:2048 lds
    buffer_load_dwordx4 v8, s[48:51], s68 offen offset:3072 lds
    s_add_u32 m0, s72, 8192
    s_xor_b32 s68, s73, 262144
    buffer_load_dwordx4 v5, s[48:51], s68 offen offset:0 lds
    buffer_load_dwordx4 v6, s[48:51], s68 offen offset:1024 lds
    buffer_load_dwordx4 v7, s[48:51], s68 offen offset:2048 lds
    buffer_load_dwordx4 v8, s[48:51], s68 offen offset:3072 lds
L_wq1:
    v_lshrrev_b32 v28, 3, v0
    v_and_b32 v14, 7, v0
    v_bfe_u32 v12, v0, 4, 1
    v_lshlrev_b32 v12, 2, v12
    v_xor_b32 v14, v14, v12
    v_lshlrev_b32 v14, 4, v14
    v_lshl_add_u32 v28, v28, 10, v14
    v_and_b32 v12, 1, v0
    v_bfe_u32 v15, v0, 1, 1
    v_lshlrev_b32 v12, 4, v12
    v_lshl_add_u32 v12, v15, 3, v12
    v_and_b32 v15, 1, v1
    v_lshl_add_u32 v12, v15, 5, v12
    v_lshl_add_u32 v12, v3, 9, v12
    v_bfe_u32 v15, v0, 2, 2
    v_lshl_add_u32 v12, v15, 7, v12
    v_bfe_u32 v15, v0, 3, 1
    v_lshl_add_u32 v12, v15, 6, v12
    v_add_u32 v12, s84, v12
    s_lshl_b32 s68, s30, 3
    s_xor_b32 s68, s68, s35
    s_lshl_b32 s68, s68, 10
    v_add_u32 v11, s68, v9
    s_waitcnt vmcnt(8)
    ds_read_b64_tr_b16 v[32:33], v16 offset:0
    ds_read_b64_tr_b16 v[34:35], v16 offset:1024
    ds_read_b64_tr_b16 v[36:37], v17 offset:0
    ds_read_b64_tr_b16 v[38:39], v17 offset:1024
    ds_read_b64_tr_b16 v[40:41], v18 offset:0
    ds_read_b64_tr_b16 v[42:43], v18 offset:1024
    ds_read_b64_tr_b16 v[44:45], v19 offset:0
    ds_read_b64_tr_b16 v[46:47], v19 offset:1024
    s_add_u32 m0, s72, 12288
    s_xor_b32 s68, s73, 393216
    buffer_load_dwordx4 v5, s[48:51], s68 offen offset:0 lds
    buffer_load_dwordx4 v6, s[48:51], s68 offen offset:1024 lds
    buffer_load_dwordx4 v7, s[48:51], s68 offen offset:2048 lds
    buffer_load_dwordx4 v8, s[48:51], s68 offen offset:3072 lds
    s_waitcnt lgkmcnt(0)
    s_waitcnt vmcnt(8)
    ds_read_b64_tr_b16 v[48:49], v16 offset:4096
    ds_read_b64_tr_b16 v[50:51], v16 offset:5120
    ds_read_b64_tr_b16 v[52:53], v17 offset:4096
    ds_read_b64_tr_b16 v[54:55], v17 offset:5120
    ds_read_b64_tr_b16 v[56:57], v18 offset:4096
    ds_read_b64_tr_b16 v[58:59], v18 offset:5120
    ds_read_b64_tr_b16 v[60:61], v19 offset:4096
    ds_read_b64_tr_b16 v[62:63], v19 offset:5120
    s_add_u32 m0, s72, 0
    s_xor_b32 s68, s73, 524288
    v_mfma_f32_32x32x16_bf16 v[64:79], v[32:35], v[128:131], 0
    buffer_load_dwordx4 v5, s[48:51], s68 offen offset:0 lds
    v_mfma_f32_32x32x16_bf16 v[80:95], v[36:39], v[128:131], 0
    buffer_load_dwordx4 v6, s[48:51], s68 offen offset:1024 lds
    v_mfma_f32_32x32x16_bf16 v[96:111], v[40:43], v[128:131], 0
    buffer_load_dwordx4 v7, s[48:51], s68 offen offset:2048 lds
    v_mfma_f32_32x32x16_bf16 v[112:127], v[44:47], v[128:131], 0
    buffer_load_dwordx4 v8, s[48:51], s68 offen offset:3072 lds
    s_waitcnt lgkmcnt(0)
    s_waitcnt vmcnt(8)
    ds_read_b64_tr_b16 v[32:33], v16 offset:8192
    ds_read_b64_tr_b16 v[34:35], v16 offset:9216
    ds_read_b64_tr_b16 v[36:37], v17 offset:8192
    ds_read_b64_tr_b16 v[38:39], v17 offset:9216
    ds_read_b64_tr_b16 v[40:41], v18 offset:8192
    ds_read_b64_tr_b16 v[42:43], v18 offset:9216
    ds_read_b64_tr_b16 v[44:45], v19 offset:8192
    ds_read_b64_tr_b16 v[46:47], v19 offset:9216
    s_add_u32 m0, s72, 4096
    s_xor_b32 s68, s73, 655360
    v_mfma_f32_32x32x16_bf16 v[64:79], v[48:51], v[132:135], v[64:79]
    buffer_load_dwordx4 v5, s[48:51], s68 offen offset:0 lds
    v_mfma_f32_32x32x16_bf16 v[80:95], v[52:55], v[132:135], v[80:95]
    buffer_load_dwordx4 v6, s[48:51], s68 offen offset:1024 lds
    v_mfma_f32_32x32x16_bf16 v[96:111], v[56:59], v[132:135], v[96:111]
    buffer_load_dwordx4 v7, s[48:51], s68 offen offset:2048 lds
    v_mfma_f32_32x32x16_bf16 v[112:127], v[60:63], v[132:135], v[112:127]
    buffer_load_dwordx4 v8, s[48:51], s68 offen offset:3072 lds
    s_waitcnt lgkmcnt(0)
    s_waitcnt vmcnt(8)
    ds_read_b64_tr_b16 v[48:49], v16 offset:12288
    ds_read_b64_tr_b16 v[50:51], v16 offset:13312
    ds_read_b64_tr_b16 v[52:53], v17 offset:12288
    ds_read_b64_tr_b16 v[54:55], v17 offset:13312
    ds_read_b64_tr_b16 v[56:57], v18 offset:12288
    ds_read_b64_tr_b16 v[58:59], v18 offset:13312
    ds_read_b64_tr_b16 v[60:61], v19 offset:12288
    ds_read_b64_tr_b16 v[62:63], v19 offset:13312
    s_add_u32 m0, s72, 8192
    s_xor_b32 s68, s73, 786432
    v_mfma_f32_32x32x16_bf16 v[64:79], v[32:35], v[136:139], v[64:79]
    buffer_load_dwordx4 v5, s[48:51], s68 offen offset:0 lds
    v_mfma_f32_32x32x16_bf16 v[80:95], v[36:39], v[136:139], v[80:95]
    buffer_load_dwordx4 v6, s[48:51], s68 offen offset:1024 lds
    v_mfma_f32_32x32x16_bf16 v[96:111], v[40:43], v[136:139], v[96:111]
    buffer_load_dwordx4 v7, s[48:51], s68 offen offset:2048 lds
    v_mfma_f32_32x32x16_bf16 v[112:127], v[44:47], v[136:139], v[112:127]
    buffer_load_dwordx4 v8, s[48:51], s68 offen offset:3072 lds
    s_waitcnt lgkmcnt(0)
    s_waitcnt vmcnt(8)
    ds_read_b64_tr_b16 v[32:33], v16 offset:0
    ds_read_b64_tr_b16 v[34:35], v16 offset:1024
    ds_read_b64_tr_b16 v[36:37], v17 offset:0
    ds_read_b64_tr_b16 v[38:39], v17 offset:1024
    ds_read_b64_tr_b16 v[40:41], v18 offset:0
    ds_read_b64_tr_b16 v[42:43], v18 offset:1024
    ds_read_b64_tr_b16 v[44:45], v19 offset:0
    ds_read_b64_tr_b16 v[46:47], v19 offset:1024
    s_add_u32 m0, s72, 12288
    s_xor_b32 s68, s73, 917504
    v_mfma_f32_32x32x16_bf16 v[64:79], v[48:51], v[140:143], v[64:79]
    buffer_load_dwordx4 v5, s[48:51], s68 offen offset:0 lds
    v_mfma_f32_32x32x16_bf16 v[80:95], v[52:55], v[140:143], v[80:95]
    buffer_load_dwordx4 v6, s[48:51], s68 offen offset:1024 lds
    v_mfma_f32_32x32x16_bf16 v[96:111], v[56:59], v[140:143], v[96:111]
    buffer_load_dwordx4 v7, s[48:51], s68 offen offset:2048 lds
    v_mfma_f32_32x32x16_bf16 v[112:127], v[60:63], v[140:143], v[112:127]
    buffer_load_dwordx4 v8, s[48:51], s68 offen offset:3072 lds
    s_waitcnt lgkmcnt(0)
    s_waitcnt vmcnt(8)
    ds_read_b64_tr_b16 v[48:49], v16 offset:4096
    ds_read_b64_tr_b16 v[50:51], v16 offset:5120
    ds_read_b64_tr_b16 v[52:53], v17 offset:4096
    ds_read_b64_tr_b16 v[54:55], v17 offset:5120
    ds_read_b64_tr_b16 v[56:57], v18 offset:4096
    ds_read_b64_tr_b16 v[58:59], v18 offset:5120
    ds_read_b64_tr_b16 v[60:61], v19 offset:4096
    ds_read_b64_tr_b16 v[62:63], v19 offset:5120
    s_add_u32 m0, s72, 0
    s_xor_b32 s68, s73, 1048576
    v_mfma_f32_32x32x16_bf16 v[64:79], v[32:35], v[144:147], v[64:79]
    buffer_load_dwordx4 v5, s[48:51], s68 offen offset:0 lds
    v_mfma_f32_32x32x16_bf16 v[80:95], v[36:39], v[144:147], v[80:95]
    buffer_load_dwordx4 v6, s[48:51], s68 offen offset:1024 lds
    v_mfma_f32_32x32x16_bf16 v[96:111], v[40:43], v[144:147], v[96:111]
    buffer_load_dwordx4 v7, s[48:51], s68 offen offset:2048 lds
    v_mfma_f32_32x32x16_bf16 v[112:127], v[44:47], v[144:147], v[112:127]
    buffer_load_dwordx4 v8, s[48:51], s68 offen offset:3072 lds
    s_waitcnt lgkmcnt(0)
    s_waitcnt vmcnt(8)
    ds_read_b64_tr_b16 v[32:33], v16 offset:8192
    ds_read_b64_tr_b16 v[34:35], v16 offset:9216
    ds_read_b64_tr_b16 v[36:37], v17 offset:8192
    ds_read_b64_tr_b16 v[38:39], v17 offset:9216
    ds_read_b64_tr_b16 v[40:41], v18 offset:8192
    ds_read_b64_tr_b16 v[42:43], v18 offset:9216
    ds_read_b64_tr_b16 v[44:45], v19 offset:8192
    ds_read_b64_tr_b16 v[46:47], v19 offset:9216
    s_add_u32 m0, s72, 4096
    s_xor_b32 s68, s73, 1179648
    v_mfma_f32_32x32x16_bf16 v[64:79], v[48:51], v[148:151], v[64:79]
    buffer_load_dwordx4 v5, s[48:51], s68 offen offset:0 lds
    v_mfma_f32_32x32x16_bf16 v[80:95], v[52:55], v[148:151], v[80:95]
    buffer_load_dwordx4 v6, s[48:51], s68 offen offset:1024 lds
    v_mfma_f32_32x32x16_bf16 v[96:111], v[56:59], v[148:151], v[96:111]
    buffer_load_dwordx4 v7, s[48:51], s68 offen offset:2048 lds
    v_mfma_f32_32x32x16_bf16 v[112:127], v[60:63], v[148:151], v[112:127]
    buffer_load_dwordx4 v8, s[48:51], s68 offen offset:3072 lds
    s_waitcnt lgkmcnt(0)
    s_waitcnt vmcnt(8)
    ds_read_b64_tr_b16 v[48:49], v16 offset:12288
    ds_read_b64_tr_b16 v[50:51], v16 offset:13312
    ds_read_b64_tr_b16 v[52:53], v17 offset:12288
    ds_read_b64_tr_b16 v[54:55], v17 offset:13312
    ds_read_b64_tr_b16 v[56:57], v18 offset:12288
    ds_read_b64_tr_b16 v[58:59], v18 offset:13312
    ds_read_b64_tr_b16 v[60:61], v19 offset:12288
    ds_read_b64_tr_b16 v[62:63], v19 offset:13312
    s_add_u32 m0, s72, 8192
    s_xor_b32 s68, s73, 1310720
    v_mfma_f32_32x32x16_bf16 v[64:79], v[32:35], v[152:155], v[64:79]
    buffer_load_dwordx4 v5, s[48:51], s68 offen offset:0 lds
    v_mfma_f32_32x32x16_bf16 v[80:95], v[36:39], v[152:155], v[80:95]
    buffer_load_dwordx4 v6, s[48:51], s68 offen offset:1024 lds
    v_mfma_f32_32x32x16_bf16 v[96:111], v[40:43], v[152:155], v[96:111]
    buffer_load_dwordx4 v7, s[48:51], s68 offen offset:2048 lds
    v_mfma_f32_32x32x16_bf16 v[112:127], v[44:47], v[152:155], v[112:127]
    buffer_load_dwordx4 v8, s[48:51], s68 offen offset:3072 lds
    s_waitcnt lgkmcnt(0)
    s_waitcnt vmcnt(8)
    ds_read_b64_tr_b16 v[32:33], v16 offset:0
    ds_read_b64_tr_b16 v[34:35], v16 offset:1024
    ds_read_b64_tr_b16 v[36:37], v17 offset:0
    ds_read_b64_tr_b16 v[38:39], v17 offset:1024
    ds_read_b64_tr_b16 v[40:41], v18 offset:0
    ds_read_b64_tr_b16 v[42:43], v18 offset:1024
    ds_read_b64_tr_b16 v[44:45], v19 offset:0
    ds_read_b64_tr_b16 v[46:47], v19 offset:1024
    s_add_u32 m0, s72, 12288
    s_xor_b32 s68, s73, 1441792
    v_mfma_f32_32x32x16_bf16 v[64:79], v[48:51], v[156:159], v[64:79]
    buffer_load_dwordx4 v5, s[48:51], s68 offen offset:0 lds
    v_mfma_f32_32x32x16_bf16 v[80:95], v[52:55], v[156:159], v[80:95]
    buffer_load_dwordx4 v6, s[48:51], s68 offen offset:1024 lds
    v_mfma_f32_32x32x16_bf16 v[96:111], v[56:59], v[156:159], v[96:111]
    buffer_load_dwordx4 v7, s[48:51], s68 offen offset:2048 lds
    v_mfma_f32_32x32x16_bf16 v[112:127], v[60:63], v[156:159], v[112:127]
    buffer_load_dwordx4 v8, s[48:51], s68 offen offset:3072 lds
    s_waitcnt lgkmcnt(0)
    s_waitcnt vmcnt(8)
    ds_read_b64_tr_b16 v[48:49], v16 offset:4096
    ds_read_b64_tr_b16 v[50:51], v16 offset:5120
    ds_read_b64_tr_b16 v[52:53], v17 offset:4096
    ds_read_b64_tr_b16 v[54:55], v17 offset:5120
    ds_read_b64_tr_b16 v[56:57], v18 offset:4096
    ds_read_b64_tr_b16 v[58:59], v18 offset:5120
    ds_read_b64_tr_b16 v[60:61], v19 offset:4096
    ds_read_b64_tr_b16 v[62:63], v19 offset:5120
    s_add_u32 m0, s72, 0
    s_xor_b32 s68, s73, 1572864
    v_mfma_f32_32x32x16_bf16 v[64:79], v[32:35], v[160:163], v[64:79]
    buffer_load_dwordx4 v5, s[48:51], s68 offen offset:0 lds
    v_mfma_f32_32x32x16_bf16 v[80:95], v[36:39], v[160:163], v[80:95]
    buffer_load_dwordx4 v6, s[48:51], s68 offen offset:1024 lds
    v_mfma_f32_32x32x16_bf16 v[96:111], v[40:43], v[160:163], v[96:111]
    buffer_load_dwordx4 v7, s[48:51], s68 offen offset:2048 lds
    v_mfma_f32_32x32x16_bf16 v[112:127], v[44:47], v[160:163], v[112:127]
    buffer_load_dwordx4 v8, s[48:51], s68 offen offset:3072 lds
    s_waitcnt lgkmcnt(0)
    s_waitcnt vmcnt(8)
    ds_read_b64_tr_b16 v[32:33], v16 offset:8192
    ds_read_b64_tr_b16 v[34:35], v16 offset:9216
    ds_read_b64_tr_b16 v[36:37], v17 offset:8192
    ds_read_b64_tr_b16 v[38:39], v17 offset:9216
    ds_read_b64_tr_b16 v[40:41], v18 offset:8192
    ds_read_b64_tr_b16 v[42:43], v18 offset:9216
    ds_read_b64_tr_b16 v[44:45], v19 offset:8192
    ds_read_b64_tr_b16 v[46:47], v19 offset:9216
    s_add_u32 m0, s72, 4096
    s_xor_b32 s68, s73, 1703936
    v_mfma_f32_32x32x16_bf16 v[64:79], v[48:51], v[164:167], v[64:79]
    buffer_load_dwordx4 v5, s[48:51], s68 offen offset:0 lds
    v_mfma_f32_32x32x16_bf16 v[80:95], v[52:55], v[164:167], v[80:95]
    buffer_load_dwordx4 v6, s[48:51], s68 offen offset:1024 lds
    v_mfma_f32_32x32x16_bf16 v[96:111], v[56:59], v[164:167], v[96:111]
    buffer_load_dwordx4 v7, s[48:51], s68 offen offset:2048 lds
    v_mfma_f32_32x32x16_bf16 v[112:127], v[60:63], v[164:167], v[112:127]
    buffer_load_dwordx4 v8, s[48:51], s68 offen offset:3072 lds
    s_waitcnt lgkmcnt(0)
    s_waitcnt vmcnt(8)
    ds_read_b64_tr_b16 v[48:49], v16 offset:12288
    ds_read_b64_tr_b16 v[50:51], v16 offset:13312
    ds_read_b64_tr_b16 v[52:53], v17 offset:12288
    ds_read_b64_tr_b16 v[54:55], v17 offset:13312
    ds_read_b64_tr_b16 v[56:57], v18 offset:12288
    ds_read_b64_tr_b16 v[58:59], v18 offset:13312
    ds_read_b64_tr_b16 v[60:61], v19 offset:12288
    ds_read_b64_tr_b16 v[62:63], v19 offset:13312
    s_add_u32 m0, s72, 8192
    s_xor_b32 s68, s73, 1835008
    v_mfma_f32_32x32x16_bf16 v[64:79], v[32:35], v[168:171], v[64:79]
    buffer_load_dwordx4 v5, s[48:51], s68 offen offset:0 lds
    v_mfma_f32_32x32x16_bf16 v[80:95], v[36:39], v[168:171], v[80:95]
    buffer_load_dwordx4 v6, s[48:51], s68 offen offset:1024 lds
    v_mfma_f32_32x32x16_bf16 v[96:111], v[40:43], v[168:171], v[96:111]
    buffer_load_dwordx4 v7, s[48:51], s68 offen offset:2048 lds
    v_mfma_f32_32x32x16_bf16 v[112:127], v[44:47], v[168:171], v[112:127]
    buffer_load_dwordx4 v8, s[48:51], s68 offen offset:3072 lds
    s_waitcnt lgkmcnt(0)
    s_waitcnt vmcnt(8)
    ds_read_b64_tr_b16 v[32:33], v16 offset:0
    ds_read_b64_tr_b16 v[34:35], v16 offset:1024
    ds_read_b64_tr_b16 v[36:37], v17 offset:0
    ds_read_b64_tr_b16 v[38:39], v17 offset:1024
    ds_read_b64_tr_b16 v[40:41], v18 offset:0
    ds_read_b64_tr_b16 v[42:43], v18 offset:1024
    ds_read_b64_tr_b16 v[44:45], v19 offset:0
    ds_read_b64_tr_b16 v[46:47], v19 offset:1024
    s_add_u32 m0, s72, 12288
    s_xor_b32 s68, s73, 1966080
    v_mfma_f32_32x32x16_bf16 v[64:79], v[48:51], v[172:175], v[64:79]
    buffer_load_dwordx4 v5, s[48:51], s68 offen offset:0 lds
    v_mfma_f32_32x32x16_bf16 v[80:95], v[52:55], v[172:175], v[80:95]
    buffer_load_dwordx4 v6, s[48:51], s68 offen offset:1024 lds
    v_mfma_f32_32x32x16_bf16 v[96:111], v[56:59], v[172:175], v[96:111]
    buffer_load_dwordx4 v7, s[48:51], s68 offen offset:2048 lds
    v_mfma_f32_32x32x16_bf16 v[112:127], v[60:63], v[172:175], v[112:127]
    buffer_load_dwordx4 v8, s[48:51], s68 offen offset:3072 lds
    s_waitcnt lgkmcnt(0)
    s_waitcnt vmcnt(8)
    ds_read_b64_tr_b16 v[48:49], v16 offset:4096
    ds_read_b64_tr_b16 v[50:51], v16 offset:5120
    ds_read_b64_tr_b16 v[52:53], v17 offset:4096
    ds_read_b64_tr_b16 v[54:55], v17 offset:5120
    ds_read_b64_tr_b16 v[56:57], v18 offset:4096
    ds_read_b64_tr_b16 v[58:59], v18 offset:5120
    ds_read_b64_tr_b16 v[60:61], v19 offset:4096
    ds_read_b64_tr_b16 v[62:63], v19 offset:5120
    s_add_u32 m0, s72, 0
    s_xor_b32 s68, s73, 2097152
    v_mfma_f32_32x32x16_bf16 v[64:79], v[32:35], v[176:179], v[64:79]
    buffer_load_dwordx4 v5, s[48:51], s68 offen offset:0 lds
    v_mfma_f32_32x32x16_bf16 v[80:95], v[36:39], v[176:179], v[80:95]
    buffer_load_dwordx4 v6, s[48:51], s68 offen offset:1024 lds
    v_mfma_f32_32x32x16_bf16 v[96:111], v[40:43], v[176:179], v[96:111]
    buffer_load_dwordx4 v7, s[48:51], s68 offen offset:2048 lds
    v_mfma_f32_32x32x16_bf16 v[112:127], v[44:47], v[176:179], v[112:127]
    buffer_load_dwordx4 v8, s[48:51], s68 offen offset:3072 lds
    s_waitcnt lgkmcnt(0)
    s_waitcnt vmcnt(8)
    ds_read_b64_tr_b16 v[32:33], v16 offset:8192
    ds_read_b64_tr_b16 v[34:35], v16 offset:9216
    ds_read_b64_tr_b16 v[36:37], v17 offset:8192
    ds_read_b64_tr_b16 v[38:39], v17 offset:9216
    ds_read_b64_tr_b16 v[40:41], v18 offset:8192
    ds_read_b64_tr_b16 v[42:43], v18 offset:9216
    ds_read_b64_tr_b16 v[44:45], v19 offset:8192
    ds_read_b64_tr_b16 v[46:47], v19 offset:9216
    s_add_u32 m0, s72, 4096
    s_xor_b32 s68, s73, 2228224
    v_mfma_f32_32x32x16_bf16 v[64:79], v[48:51], v[180:183], v[64:79]
    buffer_load_dwordx4 v5, s[48:51], s68 offen offset:0 lds
    v_mfma_f32_32x32x16_bf16 v[80:95], v[52:55], v[180:183], v[80:95]
    buffer_load_dwordx4 v6, s[48:51], s68 offen offset:1024 lds
    v_mfma_f32_32x32x16_bf16 v[96:111], v[56:59], v[180:183], v[96:111]
    buffer_load_dwordx4 v7, s[48:51], s68 offen offset:2048 lds
    v_mfma_f32_32x32x16_bf16 v[112:127], v[60:63], v[180:183], v[112:127]
    buffer_load_dwordx4 v8, s[48:51], s68 offen offset:3072 lds
    s_waitcnt lgkmcnt(0)
    s_waitcnt vmcnt(8)
    ds_read_b64_tr_b16 v[48:49], v16 offset:12288
    ds_read_b64_tr_b16 v[50:51], v16 offset:13312
    ds_read_b64_tr_b16 v[52:53], v17 offset:12288
    ds_read_b64_tr_b16 v[54:55], v17 offset:13312
    ds_read_b64_tr_b16 v[56:57], v18 offset:12288
    ds_read_b64_tr_b16 v[58:59], v18 offset:13312
    ds_read_b64_tr_b16 v[60:61], v19 offset:12288
    ds_read_b64_tr_b16 v[62:63], v19 offset:13312
    s_add_u32 m0, s72, 8192
    s_xor_b32 s68, s73, 2359296
    v_mfma_f32_32x32x16_bf16 v[64:79], v[32:35], v[184:187], v[64:79]
    buffer_load_dwordx4 v5, s[48:51], s68 offen offset:0 lds
    v_mfma_f32_32x32x16_bf16 v[80:95], v[36:39], v[184:187], v[80:95]
    buffer_load_dwordx4 v6, s[48:51], s68 offen offset:1024 lds
    v_mfma_f32_32x32x16_bf16 v[96:111], v[40:43], v[184:187], v[96:111]
    buffer_load_dwordx4 v7, s[48:51], s68 offen offset:2048 lds
    v_mfma_f32_32x32x16_bf16 v[112:127], v[44:47], v[184:187], v[112:127]
    buffer_load_dwordx4 v8, s[48:51], s68 offen offset:3072 lds
    s_waitcnt lgkmcnt(0)
    s_waitcnt vmcnt(8)
    ds_read_b64_tr_b16 v[32:33], v16 offset:0
    ds_read_b64_tr_b16 v[34:35], v16 offset:1024
    ds_read_b64_tr_b16 v[36:37], v17 offset:0
    ds_read_b64_tr_b16 v[38:39], v17 offset:1024
    ds_read_b64_tr_b16 v[40:41], v18 offset:0
    ds_read_b64_tr_b16 v[42:43], v18 offset:1024
    ds_read_b64_tr_b16 v[44:45], v19 offset:0
    ds_read_b64_tr_b16 v[46:47], v19 offset:1024
    s_add_u32 m0, s72, 12288
    s_xor_b32 s68, s73, 2490368
    v_mfma_f32_32x32x16_bf16 v[64:79], v[48:51], v[188:191], v[64:79]
    buffer_load_dwordx4 v5, s[48:51], s68 offen offset:0 lds
    v_mfma_f32_32x32x16_bf16 v[80:95], v[52:55], v[188:191], v[80:95]
    buffer_load_dwordx4 v6, s[48:51], s68 offen offset:1024 lds
    v_mfma_f32_32x32x16_bf16 v[96:111], v[56:59], v[188:191], v[96:111]
    buffer_load_dwordx4 v7, s[48:51], s68 offen offset:2048 lds
    v_mfma_f32_32x32x16_bf16 v[112:127], v[60:63], v[188:191], v[112:127]
    buffer_load_dwordx4 v8, s[48:51], s68 offen offset:3072 lds
    s_waitcnt lgkmcnt(0)
    s_waitcnt vmcnt(8)
    ds_read_b64_tr_b16 v[48:49], v16 offset:4096
    ds_read_b64_tr_b16 v[50:51], v16 offset:5120
    ds_read_b64_tr_b16 v[52:53], v17 offset:4096
    ds_read_b64_tr_b16 v[54:55], v17 offset:5120
    ds_read_b64_tr_b16 v[56:57], v18 offset:4096
    ds_read_b64_tr_b16 v[58:59], v18 offset:5120
    ds_read_b64_tr_b16 v[60:61], v19 offset:4096
    ds_read_b64_tr_b16 v[62:63], v19 offset:5120
    s_add_u32 m0, s72, 0
    s_xor_b32 s68, s73, 2621440
    v_mfma_f32_32x32x16_bf16 v[64:79], v[32:35], v[192:195], v[64:79]
    buffer_load_dwordx4 v5, s[48:51], s68 offen offset:0 lds
    v_mfma_f32_32x32x16_bf16 v[80:95], v[36:39], v[192:195], v[80:95]
    buffer_load_dwordx4 v6, s[48:51], s68 offen offset:1024 lds
    v_mfma_f32_32x32x16_bf16 v[96:111], v[40:43], v[192:195], v[96:111]
    buffer_load_dwordx4 v7, s[48:51], s68 offen offset:2048 lds
    v_mfma_f32_32x32x16_bf16 v[112:127], v[44:47], v[192:195], v[112:127]
    buffer_load_dwordx4 v8, s[48:51], s68 offen offset:3072 lds
    s_waitcnt lgkmcnt(0)
    s_waitcnt vmcnt(8)
    ds_read_b64_tr_b16 v[32:33], v16 offset:8192
    ds_read_b64_tr_b16 v[34:35], v16 offset:9216
    ds_read_b64_tr_b16 v[36:37], v17 offset:8192
    ds_read_b64_tr_b16 v[38:39], v17 offset:9216
    ds_read_b64_tr_b16 v[40:41], v18 offset:8192
    ds_read_b64_tr_b16 v[42:43], v18 offset:9216
    ds_read_b64_tr_b16 v[44:45], v19 offset:8192
    ds_read_b64_tr_b16 v[46:47], v19 offset:9216
    s_add_u32 m0, s72, 4096
    s_xor_b32 s68, s73, 2752512
    v_mfma_f32_32x32x16_bf16 v[64:79], v[48:51], v[196:199], v[64:79]
    buffer_load_dwordx4 v5, s[48:51], s68 offen offset:0 lds
    v_mov_b32 v128, 0
    v_mov_b32 v129, 0
    v_mfma_f32_32x32x16_bf16 v[80:95], v[52:55], v[196:199], v[80:95]
    buffer_load_dwordx4 v6, s[48:51], s68 offen offset:1024 lds
    v_mov_b32 v130, 0
    v_mov_b32 v131, 0
    v_mfma_f32_32x32x16_bf16 v[96:111], v[56:59], v[196:199], v[96:111]
    buffer_load_dwordx4 v7, s[48:51], s68 offen offset:2048 lds
    v_mov_b32 v132, 0
    v_mov_b32 v133, 0
    v_mfma_f32_32x32x16_bf16 v[112:127], v[60:63], v[196:199], v[112:127]
    buffer_load_dwordx4 v8, s[48:51], s68 offen offset:3072 lds
    v_mov_b32 v134, 0
    v_mov_b32 v135, 0
    s_waitcnt lgkmcnt(0)
    s_waitcnt vmcnt(8)
    ds_read_b64_tr_b16 v[48:49], v16 offset:12288
    ds_read_b64_tr_b16 v[50:51], v16 offset:13312
    ds_read_b64_tr_b16 v[52:53], v17 offset:12288
    ds_read_b64_tr_b16 v[54:55], v17 offset:13312
    ds_read_b64_tr_b16 v[56:57], v18 offset:12288
    ds_read_b64_tr_b16 v[58:59], v18 offset:13312
    ds_read_b64_tr_b16 v[60:61], v19 offset:12288
    ds_read_b64_tr_b16 v[62:63], v19 offset:13312
    s_add_u32 m0, s72, 8192
    s_xor_b32 s68, s73, 2883584
    v_mfma_f32_32x32x16_bf16 v[64:79], v[32:35], v[200:203], v[64:79]
    buffer_load_dwordx4 v5, s[48:51], s68 offen offset:0 lds
    v_mov_b32 v136, 0
    v_mov_b32 v137, 0
    v_mfma_f32_32x32x16_bf16 v[80:95], v[36:39], v[200:203], v[80:95]
    buffer_load_dwordx4 v6, s[48:51], s68 offen offset:1024 lds
    v_mov_b32 v138, 0
    v_mov_b32 v139, 0
    v_mfma_f32_32x32x16_bf16 v[96:111], v[40:43], v[200:203], v[96:111]
    buffer_load_dwordx4 v7, s[48:51], s68 offen offset:2048 lds
    v_mov_b32 v140, 0
    v_mov_b32 v141, 0
    v_mfma_f32_32x32x16_bf16 v[112:127], v[44:47], v[200:203], v[112:127]
    buffer_load_dwordx4 v8, s[48:51], s68 offen offset:3072 lds
    v_mov_b32 v142, 0
    v_mov_b32 v143, 0
    s_waitcnt lgkmcnt(0)
    s_waitcnt vmcnt(8)
    ds_read_b64_tr_b16 v[32:33], v16 offset:0
    ds_read_b64_tr_b16 v[34:35], v16 offset:1024
    ds_read_b64_tr_b16 v[36:37], v17 offset:0
    ds_read_b64_tr_b16 v[38:39], v17 offset:1024
    ds_read_b64_tr_b16 v[40:41], v18 offset:0
    ds_read_b64_tr_b16 v[42:43], v18 offset:1024
    ds_read_b64_tr_b16 v[44:45], v19 offset:0
    ds_read_b64_tr_b16 v[46:47], v19 offset:1024
    s_add_u32 m0, s72, 12288
    s_xor_b32 s68, s73, 3014656
    v_mfma_f32_32x32x16_bf16 v[64:79], v[48:51], v[204:207], v[64:79]
    buffer_load_dwordx4 v5, s[48:51], s68 offen offset:0 lds
    v_mov_b32 v144, 0
    v_mov_b32 v145, 0
    v_mfma_f32_32x32x16_bf16 v[80:95], v[52:55], v[204:207], v[80:95]
    buffer_load_dwordx4 v6, s[48:51], s68 offen offset:1024 lds
    v_mov_b32 v146, 0
    v_mov_b32 v147, 0
    v_mfma_f32_32x32x16_bf16 v[96:111], v[56:59], v[204:207], v[96:111]
    buffer_load_dwordx4 v7, s[48:51], s68 offen offset:2048 lds
    v_mov_b32 v148, 0
    v_mov_b32 v149, 0
    v_mfma_f32_32x32x16_bf16 v[112:127], v[60:63], v[204:207], v[112:127]
    buffer_load_dwordx4 v8, s[48:51], s68 offen offset:3072 lds
    v_mov_b32 v150, 0
    v_mov_b32 v151, 0
    s_waitcnt lgkmcnt(0)
    s_waitcnt vmcnt(8)
    ds_read_b64_tr_b16 v[48:49], v16 offset:4096
    ds_read_b64_tr_b16 v[50:51], v16 offset:5120
    ds_read_b64_tr_b16 v[52:53], v17 offset:4096
    ds_read_b64_tr_b16 v[54:55], v17 offset:5120
    ds_read_b64_tr_b16 v[56:57], v18 offset:4096
    ds_read_b64_tr_b16 v[58:59], v18 offset:5120
    ds_read_b64_tr_b16 v[60:61], v19 offset:4096
    ds_read_b64_tr_b16 v[62:63], v19 offset:5120
    s_add_u32 m0, s72, 0
    s_xor_b32 s68, s73, 3145728
    v_mfma_f32_32x32x16_bf16 v[64:79], v[32:35], v[208:211], v[64:79]
    buffer_load_dwordx4 v5, s[48:51], s68 offen offset:0 lds
    v_mov_b32 v152, 0
    v_mov_b32 v153, 0
    v_mfma_f32_32x32x16_bf16 v[80:95], v[36:39], v[208:211], v[80:95]
    buffer_load_dwordx4 v6, s[48:51], s68 offen offset:1024 lds
    v_mov_b32 v154, 0
    v_mov_b32 v155, 0
    v_mfma_f32_32x32x16_bf16 v[96:111], v[40:43], v[208:211], v[96:111]
    buffer_load_dwordx4 v7, s[48:51], s68 offen offset:2048 lds
    v_mov_b32 v156, 0
    v_mov_b32 v157, 0
    v_mfma_f32_32x32x16_bf16 v[112:127], v[44:47], v[208:211], v[112:127]
    buffer_load_dwordx4 v8, s[48:51], s68 offen offset:3072 lds
    v_mov_b32 v158, 0
    v_mov_b32 v159, 0
    s_waitcnt lgkmcnt(0)
    s_waitcnt vmcnt(8)
    ds_read_b64_tr_b16 v[32:33], v16 offset:8192
    ds_read_b64_tr_b16 v[34:35], v16 offset:9216
    ds_read_b64_tr_b16 v[36:37], v17 offset:8192
    ds_read_b64_tr_b16 v[38:39], v17 offset:9216
    ds_read_b64_tr_b16 v[40:41], v18 offset:8192
    ds_read_b64_tr_b16 v[42:43], v18 offset:9216
    ds_read_b64_tr_b16 v[44:45], v19 offset:8192
    ds_read_b64_tr_b16 v[46:47], v19 offset:9216
    s_add_u32 m0, s72, 4096
    s_xor_b32 s68, s73, 3276800
    v_mfma_f32_32x32x16_bf16 v[64:79], v[48:51], v[212:215], v[64:79]
    buffer_load_dwordx4 v5, s[48:51], s68 offen offset:0 lds
    v_mov_b32 v160, 0
    v_mov_b32 v161, 0
    v_mfma_f32_32x32x16_bf16 v[80:95], v[52:55], v[212:215], v[80:95]
    buffer_load_dwordx4 v6, s[48:51], s68 offen offset:1024 lds
    v_mov_b32 v162, 0
    v_mov_b32 v163, 0
    v_mfma_f32_32x32x16_bf16 v[96:111], v[56:59], v[212:215], v[96:111]
    buffer_load_dwordx4 v7, s[48:51], s68 offen offset:2048 lds
    v_mov_b32 v164, 0
    v_mov_b32 v165, 0
    v_mfma_f32_32x32x16_bf16 v[112:127], v[60:63], v[212:215], v[112:127]
    buffer_load_dwordx4 v8, s[48:51], s68 offen offset:3072 lds
    v_mov_b32 v166, 0
    v_mov_b32 v167, 0
    s_waitcnt lgkmcnt(0)
    s_waitcnt vmcnt(8)
    ds_read_b64_tr_b16 v[48:49], v16 offset:12288
    ds_read_b64_tr_b16 v[50:51], v16 offset:13312
    ds_read_b64_tr_b16 v[52:53], v17 offset:12288
    ds_read_b64_tr_b16 v[54:55], v17 offset:13312
    ds_read_b64_tr_b16 v[56:57], v18 offset:12288
    ds_read_b64_tr_b16 v[58:59], v18 offset:13312
    ds_read_b64_tr_b16 v[60:61], v19 offset:12288
    ds_read_b64_tr_b16 v[62:63], v19 offset:13312
    s_add_u32 m0, s72, 8192
    s_xor_b32 s68, s73, 3407872
    v_mfma_f32_32x32x16_bf16 v[64:79], v[32:35], v[216:219], v[64:79]
    buffer_load_dwordx4 v5, s[48:51], s68 offen offset:0 lds
    v_mov_b32 v168, 0
    v_mov_b32 v169, 0
    v_mfma_f32_32x32x16_bf16 v[80:95], v[36:39], v[216:219], v[80:95]
    buffer_load_dwordx4 v6, s[48:51], s68 offen offset:1024 lds
    v_mov_b32 v170, 0
    v_mov_b32 v171, 0
    v_mfma_f32_32x32x16_bf16 v[96:111], v[40:43], v[216:219], v[96:111]
    buffer_load_dwordx4 v7, s[48:51], s68 offen offset:2048 lds
    v_mov_b32 v172, 0
    v_mov_b32 v173, 0
    v_mfma_f32_32x32x16_bf16 v[112:127], v[44:47], v[216:219], v[112:127]
    buffer_load_dwordx4 v8, s[48:51], s68 offen offset:3072 lds
    v_mov_b32 v174, 0
    v_mov_b32 v175, 0
    s_waitcnt lgkmcnt(0)
    s_waitcnt vmcnt(8)
    ds_read_b64_tr_b16 v[32:33], v16 offset:0
    ds_read_b64_tr_b16 v[34:35], v16 offset:1024
    ds_read_b64_tr_b16 v[36:37], v17 offset:0
    ds_read_b64_tr_b16 v[38:39], v17 offset:1024
    ds_read_b64_tr_b16 v[40:41], v18 offset:0
    ds_read_b64_tr_b16 v[42:43], v18 offset:1024
    ds_read_b64_tr_b16 v[44:45], v19 offset:0
    ds_read_b64_tr_b16 v[46:47], v19 offset:1024
    s_add_u32 m0, s72, 12288
    s_xor_b32 s68, s73, 3538944
    v_mfma_f32_32x32x16_bf16 v[64:79], v[48:51], v[220:223], v[64:79]
    buffer_load_dwordx4 v5, s[48:51], s68 offen offset:0 lds
    v_mov_b32 v176, 0
    v_mov_b32 v177, 0
    v_mfma_f32_32x32x16_bf16 v[80:95], v[52:55], v[220:223], v[80:95]
    buffer_load_dwordx4 v6, s[48:51], s68 offen offset:1024 lds
    v_mov_b32 v178, 0
    v_mov_b32 v179, 0
    v_mfma_f32_32x32x16_bf16 v[96:111], v[56:59], v[220:223], v[96:111]
    buffer_load_dwordx4 v7, s[48:51], s68 offen offset:2048 lds
    v_mov_b32 v180, 0
    v_mov_b32 v181, 0
    v_mfma_f32_32x32x16_bf16 v[112:127], v[60:63], v[220:223], v[112:127]
    buffer_load_dwordx4 v8, s[48:51], s68 offen offset:3072 lds
    v_mov_b32 v182, 0
    v_mov_b32 v183, 0
    s_waitcnt lgkmcnt(0)
    s_waitcnt vmcnt(8)
    ds_read_b64_tr_b16 v[48:49], v16 offset:4096
    ds_read_b64_tr_b16 v[50:51], v16 offset:5120
    ds_read_b64_tr_b16 v[52:53], v17 offset:4096
    ds_read_b64_tr_b16 v[54:55], v17 offset:5120
    ds_read_b64_tr_b16 v[56:57], v18 offset:4096
    ds_read_b64_tr_b16 v[58:59], v18 offset:5120
    ds_read_b64_tr_b16 v[60:61], v19 offset:4096
    ds_read_b64_tr_b16 v[62:63], v19 offset:5120
    s_add_u32 m0, s72, 0
    s_xor_b32 s68, s73, 3670016
    v_mfma_f32_32x32x16_bf16 v[64:79], v[32:35], v[224:227], v[64:79]
    buffer_load_dwordx4 v5, s[48:51], s68 offen offset:0 lds
    v_mov_b32 v184, 0
    v_mov_b32 v185, 0
    v_mfma_f32_32x32x16_bf16 v[80:95], v[36:39], v[224:227], v[80:95]
    buffer_load_dwordx4 v6, s[48:51], s68 offen offset:1024 lds
    v_mov_b32 v186, 0
    v_mov_b32 v187, 0
    v_mfma_f32_32x32x16_bf16 v[96:111], v[40:43], v[224:227], v[96:111]
    buffer_load_dwordx4 v7, s[48:51], s68 offen offset:2048 lds
    v_mov_b32 v188, 0
    v_mov_b32 v189, 0
    v_mfma_f32_32x32x16_bf16 v[112:127], v[44:47], v[224:227], v[112:127]
    buffer_load_dwordx4 v8, s[48:51], s68 offen offset:3072 lds
    v_mov_b32 v190, 0
    v_mov_b32 v191, 0
    s_waitcnt lgkmcnt(0)
    s_waitcnt vmcnt(8)
    ds_read_b64_tr_b16 v[32:33], v16 offset:8192
    ds_read_b64_tr_b16 v[34:35], v16 offset:9216
    ds_read_b64_tr_b16 v[36:37], v17 offset:8192
    ds_read_b64_tr_b16 v[38:39], v17 offset:9216
    ds_read_b64_tr_b16 v[40:41], v18 offset:8192
    ds_read_b64_tr_b16 v[42:43], v18 offset:9216
    ds_read_b64_tr_b16 v[44:45], v19 offset:8192
    ds_read_b64_tr_b16 v[46:47], v19 offset:9216
    s_add_u32 m0, s72, 4096
    s_xor_b32 s68, s73, 3801088
    v_mfma_f32_32x32x16_bf16 v[64:79], v[48:51], v[228:231], v[64:79]
    buffer_load_dwordx4 v5, s[48:51], s68 offen offset:0 lds
    v_mfma_f32_32x32x16_bf16 v[80:95], v[52:55], v[228:231], v[80:95]
    buffer_load_dwordx4 v6, s[48:51], s68 offen offset:1024 lds
    v_mfma_f32_32x32x16_bf16 v[96:111], v[56:59], v[228:231], v[96:111]
    buffer_load_dwordx4 v7, s[48:51], s68 offen offset:2048 lds
    v_mfma_f32_32x32x16_bf16 v[112:127], v[60:63], v[228:231], v[112:127]
    buffer_load_dwordx4 v8, s[48:51], s68 offen offset:3072 lds
    s_waitcnt lgkmcnt(0)
    s_waitcnt vmcnt(8)
    ds_read_b64_tr_b16 v[48:49], v16 offset:12288
    ds_read_b64_tr_b16 v[50:51], v16 offset:13312
    ds_read_b64_tr_b16 v[52:53], v17 offset:12288
    ds_read_b64_tr_b16 v[54:55], v17 offset:13312
    ds_read_b64_tr_b16 v[56:57], v18 offset:12288
    ds_read_b64_tr_b16 v[58:59], v18 offset:13312
    ds_read_b64_tr_b16 v[60:61], v19 offset:12288
    ds_read_b64_tr_b16 v[62:63], v19 offset:13312
    s_add_u32 m0, s72, 8192
    s_xor_b32 s68, s73, 3932160
    v_mfma_f32_32x32x16_bf16 v[64:79], v[32:35], v[232:235], v[64:79]
    buffer_load_dwordx4 v5, s[48:51], s68 offen offset:0 lds
    v_mfma_f32_32x32x16_bf16 v[80:95], v[36:39], v[232:235], v[80:95]
    buffer_load_dwordx4 v6, s[48:51], s68 offen offset:1024 lds
    v_mfma_f32_32x32x16_bf16 v[96:111], v[40:43], v[232:235], v[96:111]
    buffer_load_dwordx4 v7, s[48:51], s68 offen offset:2048 lds
    v_mfma_f32_32x32x16_bf16 v[112:127], v[44:47], v[232:235], v[112:127]
    buffer_load_dwordx4 v8, s[48:51], s68 offen offset:3072 lds
    s_waitcnt lgkmcnt(0)
    s_waitcnt vmcnt(8)
    ds_read_b64_tr_b16 v[32:33], v16 offset:0
    ds_read_b64_tr_b16 v[34:35], v16 offset:1024
    ds_read_b64_tr_b16 v[36:37], v17 offset:0
    ds_read_b64_tr_b16 v[38:39], v17 offset:1024
    ds_read_b64_tr_b16 v[40:41], v18 offset:0
    ds_read_b64_tr_b16 v[42:43], v18 offset:1024
    ds_read_b64_tr_b16 v[44:45], v19 offset:0
    ds_read_b64_tr_b16 v[46:47], v19 offset:1024
    s_add_u32 m0, s72, 12288
    s_xor_b32 s68, s73, 4063232
    v_mfma_f32_32x32x16_bf16 v[64:79], v[48:51], v[236:239], v[64:79]
    buffer_load_dwordx4 v5, s[48:51], s68 offen offset:0 lds
    v_mfma_f32_32x32x16_bf16 v[80:95], v[52:55], v[236:239], v[80:95]
    buffer_load_dwordx4 v6, s[48:51], s68 offen offset:1024 lds
    v_mfma_f32_32x32x16_bf16 v[96:111], v[56:59], v[236:239], v[96:111]
    buffer_load_dwordx4 v7, s[48:51], s68 offen offset:2048 lds
    v_mfma_f32_32x32x16_bf16 v[112:127], v[60:63], v[236:239], v[112:127]
    buffer_load_dwordx4 v8, s[48:51], s68 offen offset:3072 lds
    s_barrier
    s_waitcnt lgkmcnt(0)
    s_waitcnt vmcnt(8)
    ds_read_b64_tr_b16 v[48:49], v16 offset:4096
    ds_read_b64_tr_b16 v[50:51], v16 offset:5120
    ds_read_b64_tr_b16 v[52:53], v17 offset:4096
    ds_read_b64_tr_b16 v[54:55], v17 offset:5120
    ds_read_b64_tr_b16 v[56:57], v18 offset:4096
    ds_read_b64_tr_b16 v[58:59], v18 offset:5120
    ds_read_b64_tr_b16 v[60:61], v19 offset:4096
    ds_read_b64_tr_b16 v[62:63], v19 offset:5120
    v_mfma_f32_32x32x16_bf16 v[64:79], v[32:35], v[240:243], v[64:79]
    v_mfma_f32_32x32x16_bf16 v[80:95], v[36:39], v[240:243], v[80:95]
    v_mfma_f32_32x32x16_bf16 v[96:111], v[40:43], v[240:243], v[96:111]
    v_mfma_f32_32x32x16_bf16 v[112:127], v[44:47], v[240:243], v[112:127]
    s_waitcnt lgkmcnt(0)
    s_waitcnt vmcnt(4)
    ds_read_b64_tr_b16 v[32:33], v16 offset:8192
    ds_read_b64_tr_b16 v[34:35], v16 offset:9216
    ds_read_b64_tr_b16 v[36:37], v17 offset:8192
    ds_read_b64_tr_b16 v[38:39], v17 offset:9216
    ds_read_b64_tr_b16 v[40:41], v18 offset:8192
    ds_read_b64_tr_b16 v[42:43], v18 offset:9216
    ds_read_b64_tr_b16 v[44:45], v19 offset:8192
    ds_read_b64_tr_b16 v[46:47], v19 offset:9216
    v_mfma_f32_32x32x16_bf16 v[64:79], v[48:51], v[244:247], v[64:79]
    v_mfma_f32_32x32x16_bf16 v[80:95], v[52:55], v[244:247], v[80:95]
    v_mfma_f32_32x32x16_bf16 v[96:111], v[56:59], v[244:247], v[96:111]
    v_mfma_f32_32x32x16_bf16 v[112:127], v[60:63], v[244:247], v[112:127]
    s_waitcnt lgkmcnt(0)
    s_waitcnt vmcnt(0)
    ds_read_b64_tr_b16 v[48:49], v16 offset:12288
    ds_read_b64_tr_b16 v[50:51], v16 offset:13312
    ds_read_b64_tr_b16 v[52:53], v17 offset:12288
    ds_read_b64_tr_b16 v[54:55], v17 offset:13312
    ds_read_b64_tr_b16 v[56:57], v18 offset:12288
    ds_read_b64_tr_b16 v[58:59], v18 offset:13312
    ds_read_b64_tr_b16 v[60:61], v19 offset:12288
    ds_read_b64_tr_b16 v[62:63], v19 offset:13312
    v_mfma_f32_32x32x16_bf16 v[64:79], v[32:35], v[248:251], v[64:79]
    s_waitcnt lgkmcnt(0)
    s_barrier
    s_mov_b32 s71, 14
    s_mov_b32 s72, 0
    s_mov_b32 s73, 163840
    v_mfma_f32_32x32x16_bf16 v[64:79], v[48:51], v[252:255], v[64:79]
    v_add_u32 v16, s72, v29
    v_xor_b32 v17, 64, v16
    v_xor_b32 v18, 128, v16
    v_xor_b32 v19, 192, v16
    v_mfma_f32_32x32x16_bf16 v[80:95], v[36:39], v[248:251], v[80:95]
    s_mov_b32 s78, 16384
    v_add_u32 v20, s78, v13
    v_xor_b32 v21, 32, v20
    v_xor_b32 v22, 64, v20
    v_mfma_f32_32x32x16_bf16 v[80:95], v[52:55], v[252:255], v[80:95]
    v_xor_b32 v23, 96, v20
    v_xor_b32 v24, 128, v20
    v_xor_b32 v25, 160, v20
    v_mfma_f32_32x32x16_bf16 v[96:111], v[40:43], v[248:251], v[96:111]
    v_pk_mul_f32 v[64:65], v[64:65], v[30:31] op_sel_hi:[1,0]
    v_pk_mul_f32 v[66:67], v[66:67], v[30:31] op_sel_hi:[1,0]
    v_pk_mul_f32 v[68:69], v[68:69], v[30:31] op_sel_hi:[1,0]
    v_pk_mul_f32 v[70:71], v[70:71], v[30:31] op_sel_hi:[1,0]
    v_mfma_f32_32x32x16_bf16 v[96:111], v[56:59], v[252:255], v[96:111]
    v_pk_mul_f32 v[72:73], v[72:73], v[30:31] op_sel_hi:[1,0]
    v_pk_mul_f32 v[74:75], v[74:75], v[30:31] op_sel_hi:[1,0]
    v_pk_mul_f32 v[76:77], v[76:77], v[30:31] op_sel_hi:[1,0]
    v_pk_mul_f32 v[78:79], v[78:79], v[30:31] op_sel_hi:[1,0]
    v_mfma_f32_32x32x16_bf16 v[112:127], v[44:47], v[248:251], v[112:127]
    v_pk_mul_f32 v[80:81], v[80:81], v[30:31] op_sel_hi:[1,0]
    v_pk_mul_f32 v[82:83], v[82:83], v[30:31] op_sel_hi:[1,0]
    v_pk_mul_f32 v[84:85], v[84:85], v[30:31] op_sel_hi:[1,0]
    v_pk_mul_f32 v[86:87], v[86:87], v[30:31] op_sel_hi:[1,0]
    v_mfma_f32_32x32x16_bf16 v[112:127], v[60:63], v[252:255], v[112:127]
    v_pk_mul_f32 v[88:89], v[88:89], v[30:31] op_sel_hi:[1,0]
    v_pk_mul_f32 v[90:91], v[90:91], v[30:31] op_sel_hi:[1,0]
    v_pk_mul_f32 v[92:93], v[92:93], v[30:31] op_sel_hi:[1,0]
    v_pk_mul_f32 v[94:95], v[94:95], v[30:31] op_sel_hi:[1,0]
    v_cvt_pk_bf16_f32 v32, v64, v65
    v_cvt_pk_bf16_f32 v33, v66, v67
    v_cvt_pk_bf16_f32 v34, v68, v69
    v_cvt_pk_bf16_f32 v35, v70, v71
    v_cvt_pk_bf16_f32 v36, v72, v73
    v_cvt_pk_bf16_f32 v37, v74, v75
    v_cvt_pk_bf16_f32 v38, v76, v77
    v_cvt_pk_bf16_f32 v39, v78, v79
    v_cvt_pk_bf16_f32 v40, v80, v81
    v_cvt_pk_bf16_f32 v41, v82, v83
    v_cvt_pk_bf16_f32 v42, v84, v85
    v_cvt_pk_bf16_f32 v43, v86, v87
    v_cvt_pk_bf16_f32 v44, v88, v89
    v_cvt_pk_bf16_f32 v45, v90, v91
    v_cvt_pk_bf16_f32 v46, v92, v93
    v_cvt_pk_bf16_f32 v47, v94, v95
    s_barrier
    ds_read_b128 v[192:195], v16 offset:0
    ds_read_b128 v[196:199], v16 offset:4096
    ds_read_b128 v[200:203], v17 offset:0
    ds_read_b128 v[204:207], v17 offset:4096
    ds_read_b128 v[208:211], v18 offset:0
    ds_read_b128 v[212:215], v18 offset:4096
    ds_read_b128 v[216:219], v19 offset:0
    ds_read_b128 v[220:223], v19 offset:4096
    s_mov_b32 s72, 32768
    v_pk_mul_f32 v[96:97], v[96:97], v[30:31] op_sel_hi:[1,0]
    v_pk_mul_f32 v[98:99], v[98:99], v[30:31] op_sel_hi:[1,0]
    v_pk_mul_f32 v[100:101], v[100:101], v[30:31] op_sel_hi:[1,0]
    v_pk_mul_f32 v[102:103], v[102:103], v[30:31] op_sel_hi:[1,0]
    v_pk_mul_f32 v[104:105], v[104:105], v[30:31] op_sel_hi:[1,0]
    v_pk_mul_f32 v[106:107], v[106:107], v[30:31] op_sel_hi:[1,0]
    v_pk_mul_f32 v[108:109], v[108:109], v[30:31] op_sel_hi:[1,0]
    v_pk_mul_f32 v[110:111], v[110:111], v[30:31] op_sel_hi:[1,0]
    v_permlane32_swap_b32 v32, v36
    v_permlane32_swap_b32 v33, v37
    v_permlane32_swap_b32 v34, v38
    v_permlane32_swap_b32 v35, v39
    v_permlane16_swap_b32 v32, v36
    v_permlane16_swap_b32 v33, v37
    v_permlane16_swap_b32 v34, v38
    v_permlane16_swap_b32 v35, v39
    v_cvt_pk_bf16_f32 v48, v96, v97
    v_cvt_pk_bf16_f32 v49, v98, v99
    v_cvt_pk_bf16_f32 v50, v100, v101
    v_cvt_pk_bf16_f32 v51, v102, v103
    v_cvt_pk_bf16_f32 v52, v104, v105
    v_cvt_pk_bf16_f32 v53, v106, v107
    v_cvt_pk_bf16_f32 v54, v108, v109
    v_cvt_pk_bf16_f32 v55, v110, v111
    v_pk_mul_f32 v[112:113], v[112:113], v[30:31] op_sel_hi:[1,0]
    v_pk_mul_f32 v[114:115], v[114:115], v[30:31] op_sel_hi:[1,0]
    v_pk_mul_f32 v[116:117], v[116:117], v[30:31] op_sel_hi:[1,0]
    v_pk_mul_f32 v[118:119], v[118:119], v[30:31] op_sel_hi:[1,0]
    v_pk_mul_f32 v[120:121], v[120:121], v[30:31] op_sel_hi:[1,0]
    v_pk_mul_f32 v[122:123], v[122:123], v[30:31] op_sel_hi:[1,0]
    v_pk_mul_f32 v[124:125], v[124:125], v[30:31] op_sel_hi:[1,0]
    v_pk_mul_f32 v[126:127], v[126:127], v[30:31] op_sel_hi:[1,0]
    v_permlane32_swap_b32 v40, v44
    v_permlane32_swap_b32 v41, v45
    v_permlane32_swap_b32 v42, v46
    v_permlane32_swap_b32 v43, v47
    v_permlane16_swap_b32 v40, v44
    v_permlane16_swap_b32 v41, v45
    v_permlane16_swap_b32 v42, v46
    v_permlane16_swap_b32 v43, v47
    v_cvt_pk_bf16_f32 v56, v112, v113
    v_cvt_pk_bf16_f32 v57, v114, v115
    v_cvt_pk_bf16_f32 v58, v116, v117
    v_cvt_pk_bf16_f32 v59, v118, v119
    v_cvt_pk_bf16_f32 v60, v120, v121
    v_cvt_pk_bf16_f32 v61, v122, v123
    v_cvt_pk_bf16_f32 v62, v124, v125
    v_cvt_pk_bf16_f32 v63, v126, v127
    s_waitcnt lgkmcnt(7)
    v_mfma_f32_16x16x32_bf16 v[64:67], v[192:195], v[32:35], 0
    v_xor_b32 v26, 192, v20
    v_xor_b32 v27, 224, v20
    v_mfma_f32_16x16x32_bf16 v[72:75], v[192:195], v[36:39], 0
    ds_read_b128 v[192:195], v16 offset:8192
    v_permlane32_swap_b32 v48, v52
    v_permlane32_swap_b32 v49, v53
    s_waitcnt lgkmcnt(7)
    v_mfma_f32_16x16x32_bf16 v[68:71], v[196:199], v[32:35], 0
    v_permlane32_swap_b32 v50, v54
    v_permlane32_swap_b32 v51, v55
    v_mfma_f32_16x16x32_bf16 v[76:79], v[196:199], v[36:39], 0
    ds_read_b128 v[196:199], v16 offset:12288
    v_permlane16_swap_b32 v48, v52
    v_permlane16_swap_b32 v49, v53
    s_waitcnt lgkmcnt(7)
    v_mfma_f32_16x16x32_bf16 v[64:67], v[200:203], v[40:43], v[64:67]
    v_permlane16_swap_b32 v50, v54
    v_permlane16_swap_b32 v51, v55
    v_mfma_f32_16x16x32_bf16 v[72:75], v[200:203], v[44:47], v[72:75]
    ds_read_b128 v[200:203], v17 offset:8192
    v_permlane32_swap_b32 v56, v60
    v_permlane32_swap_b32 v57, v61
    s_waitcnt lgkmcnt(7)
    v_mfma_f32_16x16x32_bf16 v[68:71], v[204:207], v[40:43], v[68:71]
    v_permlane32_swap_b32 v58, v62
    v_permlane32_swap_b32 v59, v63
    v_mfma_f32_16x16x32_bf16 v[76:79], v[204:207], v[44:47], v[76:79]
    ds_read_b128 v[204:207], v17 offset:12288
    v_permlane16_swap_b32 v56, v60
    v_permlane16_swap_b32 v57, v61
    s_waitcnt lgkmcnt(7)
    v_mfma_f32_16x16x32_bf16 v[64:67], v[208:211], v[48:51], v[64:67]
    v_permlane16_swap_b32 v58, v62
    v_permlane16_swap_b32 v59, v63
    v_mfma_f32_16x16x32_bf16 v[72:75], v[208:211], v[52:55], v[72:75]
    ds_read_b128 v[208:211], v18 offset:8192
    v_mov_b32 v104, 0
    v_mov_b32 v105, 0
    s_waitcnt lgkmcnt(7)
    v_mfma_f32_16x16x32_bf16 v[68:71], v[212:215], v[48:51], v[68:71]
    v_mov_b32 v106, 0
    v_mov_b32 v107, 0
    v_mfma_f32_16x16x32_bf16 v[76:79], v[212:215], v[52:55], v[76:79]
    ds_read_b128 v[212:215], v18 offset:12288
    v_mov_b32 v108, 0
    v_mov_b32 v109, 0
    s_waitcnt lgkmcnt(7)
    v_mfma_f32_16x16x32_bf16 v[64:67], v[216:219], v[56:59], v[64:67]
    v_mov_b32 v110, 0
    v_mov_b32 v111, 0
    v_mfma_f32_16x16x32_bf16 v[72:75], v[216:219], v[60:63], v[72:75]
    ds_read_b128 v[216:219], v19 offset:8192
    v_mov_b32 v124, 0x3f803f80
    v_mov_b32 v125, 0x3f803f80
    s_waitcnt lgkmcnt(7)
    v_mfma_f32_16x16x32_bf16 v[68:71], v[220:223], v[56:59], v[68:71]
    v_mov_b32 v126, 0x3f803f80
    v_mov_b32 v127, 0x3f803f80
    v_mfma_f32_16x16x32_bf16 v[76:79], v[220:223], v[60:63], v[76:79]
    ds_read_b128 v[220:223], v19 offset:12288
    v_add_u32 v16, s72, v29
    v_xor_b32 v17, 64, v16
    v_xor_b32 v18, 128, v16
    v_xor_b32 v19, 192, v16
    s_nop 2
    v_max3_f32 v14, v64, v65, v66
    v_max3_f32 v15, v67, v68, v69
    v_max3_f32 v14, v14, v70, v71
    v_max3_f32 v6, v72, v73, v74
    v_max3_f32 v7, v75, v76, v77
    v_max3_f32 v6, v6, v78, v79
    v_max_f32 v14, v14, v15
    v_max_f32 v6, v6, v7
    v_mov_b32 v15, v14
    v_mov_b32 v7, v6
    s_waitcnt lgkmcnt(0)
    s_barrier
    ds_read_b64_tr_b16 v[224:225], v20 offset:0
    ds_read_b64_tr_b16 v[226:227], v20 offset:4096
    ds_read_b64_tr_b16 v[228:229], v21 offset:0
    ds_read_b64_tr_b16 v[230:231], v21 offset:4096
    ds_read_b64_tr_b16 v[232:233], v22 offset:0
    ds_read_b64_tr_b16 v[234:235], v22 offset:4096
    ds_read_b64_tr_b16 v[236:237], v23 offset:0
    ds_read_b64_tr_b16 v[238:239], v23 offset:4096
    ds_read_b64_tr_b16 v[240:241], v24 offset:0
    v_permlane32_swap_b32 v14, v15
    v_permlane32_swap_b32 v6, v7
    v_max_f32 v14, v14, v15
    v_max_f32 v6, v6, v7
    v_mov_b32 v15, v14
    v_mov_b32 v7, v6
    s_nop 0
    v_permlane16_swap_b32 v14, v15
    v_permlane16_swap_b32 v6, v7
    v_max_f32 v14, v14, v15
    v_max_f32 v6, v6, v7
    v_sub_f32 v112, 0, v14
    v_sub_f32 v113, 0, v14
    v_sub_f32 v114, 0, v14
    v_sub_f32 v115, 0, v14
    v_sub_f32 v64, v64, v14
    v_sub_f32 v65, v65, v14
    v_sub_f32 v66, v66, v14
    v_sub_f32 v67, v67, v14
    v_sub_f32 v68, v68, v14
    v_sub_f32 v69, v69, v14
    v_sub_f32 v70, v70, v14
    v_sub_f32 v71, v71, v14
    v_sub_f32 v116, 0, v6
    v_sub_f32 v117, 0, v6
    v_sub_f32 v118, 0, v6
    v_sub_f32 v119, 0, v6
    v_sub_f32 v72, v72, v6
    v_sub_f32 v73, v73, v6
    v_sub_f32 v74, v74, v6
    v_sub_f32 v75, v75, v6
    v_sub_f32 v76, v76, v6
    v_sub_f32 v77, v77, v6
    v_sub_f32 v78, v78, v6
    v_sub_f32 v79, v79, v6
    s_lshl_b32 s68, s34, 3
    v_mov_b32 v30, s68
    v_mov_b32 v5, 8
    s_mov_b32 s75, 99
    s_cmp_eq_u32 s30, 0
    s_cbranch_scc0 L_noann
    s_mov_b32 s75, 1
    v_mov_b32 v10, 1
    s_mov_b64 exec, 1
    buffer_atomic_add v10, v30, s[64:67], 0 offen sc1
    s_mov_b64 exec, -1
L_noann:
L_loop:
    v_mfma_f32_16x16x32_bf16 v[80:83], v[192:195], v[32:35], v[112:115]
    ds_read_b64_tr_b16 v[242:243], v24 offset:4096
    v_exp_f32 v64, v64
    v_mfma_f32_16x16x32_bf16 v[88:91], v[192:195], v[36:39], v[116:119]
    v_exp_f32 v65, v65
    s_add_u32 s78, s72, 16384
    v_mfma_f32_16x16x32_bf16 v[84:87], v[196:199], v[32:35], v[112:115]
    ds_read_b64_tr_b16 v[244:245], v25 offset:0
    v_exp_f32 v66, v66
    v_mfma_f32_16x16x32_bf16 v[92:95], v[196:199], v[36:39], v[116:119]
    ds_read_b128 v[192:195], v16 offset:0
    v_exp_f32 v67, v67
    v_mfma_f32_16x16x32_bf16 v[80:83], v[200:203], v[40:43], v[80:83]
    ds_read_b64_tr_b16 v[246:247], v25 offset:4096
    v_exp_f32 v68, v68
    v_mfma_f32_16x16x32_bf16 v[88:91], v[200:203], v[44:47], v[88:91]
    ds_read_b128 v[196:199], v16 offset:4096
    v_exp_f32 v69, v69
    v_mfma_f32_16x16x32_bf16 v[84:87], v[204:207], v[40:43], v[84:87]
    ds_read_b64_tr_b16 v[248:249], v26 offset:0
    v_exp_f32 v70, v70
    v_mfma_f32_16x16x32_bf16 v[92:95], v[204:207], v[44:47], v[92:95]
    s_waitcnt lgkmcnt(6)
    v_exp_f32 v71, v71
    v_mfma_f32_16x16x32_bf16 v[80:83], v[208:211], v[48:51], v[80:83]
    ds_read_b128 v[200:203], v17 offset:0
    ds_read_b64_tr_b16 v[250:251], v26 offset:4096
    v_cvt_pk_bf16_f32 v96, v64, v65
    v_mfma_f32_16x16x32_bf16 v[88:91], v[208:211], v[52:55], v[88:91]
    ds_read_b128 v[204:207], v17 offset:4096
    v_cvt_pk_bf16_f32 v97, v66, v67
    s_add_u32 s72, s72, 32768
    v_mfma_f32_16x16x32_bf16 v[84:87], v[212:215], v[48:51], v[84:87]
    ds_read_b64_tr_b16 v[252:253], v27 offset:0
    v_cvt_pk_bf16_f32 v98, v68, v69
    s_cmp_eq_u32 s72, s73
    v_mfma_f32_16x16x32_bf16 v[92:95], v[212:215], v[52:55], v[92:95]
    ds_read_b128 v[208:211], v18 offset:0
    v_cvt_pk_bf16_f32 v99, v70, v71
    s_cselect_b32 s72, 0, s72
    v_mfma_f32_16x16x32_bf16 v[80:83], v[216:219], v[56:59], v[80:83]
    ds_read_b64_tr_b16 v[254:255], v27 offset:4096
    v_exp_f32 v72, v72
    v_mfma_f32_16x16x32_bf16 v[88:91], v[216:219], v[60:63], v[88:91]
    ds_read_b128 v[212:215], v18 offset:4096
    v_exp_f32 v73, v73
    v_mfma_f32_16x16x32_bf16 v[84:87], v[220:223], v[56:59], v[84:87]
    v_exp_f32 v74, v74
    s_cselect_b32 s73, 131072, s73
    v_mfma_f32_16x16x32_bf16 v[92:95], v[220:223], v[60:63], v[92:95]
    ds_read_b128 v[216:219], v19 offset:0
    v_exp_f32 v75, v75
    v_mfma_f32_16x16x32_bf16 v[128:131], v[224:227], v[96:99], v[128:131]
    v_exp_f32 v76, v76
    s_cmp_eq_u32 s71, s75
    s_cbranch_scc0 L_nock
    buffer_load_dword v5, v30, s[64:67], 0 offen sc1
L_nock:
    v_mfma_f32_16x16x32_bf16 v[136:139], v[228:231], v[96:99], v[136:139]
    ds_read_b128 v[220:223], v19 offset:4096
    v_exp_f32 v77, v77
    v_mfma_f32_16x16x32_bf16 v[144:147], v[232:235], v[96:99], v[144:147]
    v_exp_f32 v78, v78
    v_mfma_f32_16x16x32_bf16 v[152:155], v[236:239], v[96:99], v[152:155]
    v_exp_f32 v79, v79
    s_waitcnt lgkmcnt(3)
    v_mfma_f32_16x16x32_bf16 v[160:163], v[240:243], v[96:99], v[160:163]
    v_cvt_pk_bf16_f32 v100, v72, v73
    v_cvt_pk_bf16_f32 v101, v74, v75
    v_mfma_f32_16x16x32_bf16 v[168:171], v[244:247], v[96:99], v[168:171]
    v_cvt_pk_bf16_f32 v102, v76, v77
    v_cvt_pk_bf16_f32 v103, v78, v79
    v_mfma_f32_16x16x32_bf16 v[176:179], v[248:251], v[96:99], v[176:179]
    v_max3_f32 v14, v80, v81, v82
    s_sub_u32 s71, s71, 1
    v_mfma_f32_16x16x32_bf16 v[184:187], v[252:255], v[96:99], v[184:187]
    v_max3_f32 v15, v83, v88, v89
    v_mfma_f32_16x16x32_bf16 v[104:107], v[124:127], v[96:99], v[104:107]
    s_waitcnt lgkmcnt(0)
    v_mfma_f32_16x16x32_bf16 v[132:135], v[224:227], v[100:103], v[132:135]
    ds_read_b64_tr_b16 v[224:225], v20 offset:8192
    v_max3_f32 v14, v14, v90, v91
    v_mfma_f32_16x16x32_bf16 v[140:143], v[228:231], v[100:103], v[140:143]
    ds_read_b64_tr_b16 v[226:227], v20 offset:12288
    v_max3_f32 v15, v15, v84, v85
    v_mfma_f32_16x16x32_bf16 v[148:151], v[232:235], v[100:103], v[148:151]
    ds_read_b64_tr_b16 v[228:229], v21 offset:8192
    v_max3_f32 v14, v14, v86, v87
    v_mfma_f32_16x16x32_bf16 v[156:159], v[236:239], v[100:103], v[156:159]
    ds_read_b64_tr_b16 v[230:231], v21 offset:12288
    v_max3_f32 v15, v15, v92, v93
    v_mfma_f32_16x16x32_bf16 v[164:167], v[240:243], v[100:103], v[164:167]
    ds_read_b64_tr_b16 v[232:233], v22 offset:8192
    v_max3_f32 v14, v14, v94, v95
    v_mfma_f32_16x16x32_bf16 v[172:175], v[244:247], v[100:103], v[172:175]
    ds_read_b64_tr_b16 v[234:235], v22 offset:12288
    v_max_f32 v14, v14, v15
    v_mfma_f32_16x16x32_bf16 v[180:183], v[248:251], v[100:103], v[180:183]
    ds_read_b64_tr_b16 v[236:237], v23 offset:8192
    v_cmp_lt_f32 vcc, s74, v14
    v_mfma_f32_16x16x32_bf16 v[188:191], v[252:255], v[100:103], v[188:191]
    ds_read_b64_tr_b16 v[238:239], v23 offset:12288
    v_mfma_f32_16x16x32_bf16 v[108:111], v[124:127], v[100:103], v[108:111]
    ds_read_b64_tr_b16 v[240:241], v24 offset:8192
    s_cbranch_vccnz L_slowA
L_backA:
    v_mfma_f32_16x16x32_bf16 v[64:67], v[192:195], v[32:35], v[112:115]
    ds_read_b64_tr_b16 v[242:243], v24 offset:12288
    v_exp_f32 v80, v80
    v_mfma_f32_16x16x32_bf16 v[72:75], v[192:195], v[36:39], v[116:119]
    v_exp_f32 v81, v81
    v_add_u32 v20, s78, v13
    v_mfma_f32_16x16x32_bf16 v[68:71], v[196:199], v[32:35], v[112:115]
    ds_read_b64_tr_b16 v[244:245], v25 offset:8192
    v_exp_f32 v82, v82
    v_mfma_f32_16x16x32_bf16 v[76:79], v[196:199], v[36:39], v[116:119]
    ds_read_b128 v[192:195], v16 offset:8192
    v_exp_f32 v83, v83
    v_mfma_f32_16x16x32_bf16 v[64:67], v[200:203], v[40:43], v[64:67]
    ds_read_b64_tr_b16 v[246:247], v25 offset:12288
    v_exp_f32 v84, v84
    v_mfma_f32_16x16x32_bf16 v[72:75], v[200:203], v[44:47], v[72:75]
    ds_read_b128 v[196:199], v16 offset:12288
    v_exp_f32 v85, v85
    v_mfma_f32_16x16x32_bf16 v[68:71], v[204:207], v[40:43], v[68:71]
    ds_read_b64_tr_b16 v[248:249], v26 offset:8192
    v_exp_f32 v86, v86
    v_mfma_f32_16x16x32_bf16 v[76:79], v[204:207], v[44:47], v[76:79]
    s_waitcnt lgkmcnt(6)
    v_exp_f32 v87, v87
    v_mfma_f32_16x16x32_bf16 v[64:67], v[208:211], v[48:51], v[64:67]
    ds_read_b128 v[200:203], v17 offset:8192
    ds_read_b64_tr_b16 v[250:251], v26 offset:12288
    v_cvt_pk_bf16_f32 v96, v80, v81
    v_mfma_f32_16x16x32_bf16 v[72:75], v[208:211], v[52:55], v[72:75]
    ds_read_b128 v[204:207], v17 offset:12288
    v_cvt_pk_bf16_f32 v97, v82, v83
    v_xor_b32 v21, 32, v20
    v_mfma_f32_16x16x32_bf16 v[68:71], v[212:215], v[48:51], v[68:71]
    ds_read_b64_tr_b16 v[252:253], v27 offset:8192
    v_cvt_pk_bf16_f32 v98, v84, v85
    v_xor_b32 v22, 64, v20
    v_mfma_f32_16x16x32_bf16 v[76:79], v[212:215], v[52:55], v[76:79]
    ds_read_b128 v[208:211], v18 offset:8192
    v_cvt_pk_bf16_f32 v99, v86, v87
    v_xor_b32 v23, 96, v20
    v_mfma_f32_16x16x32_bf16 v[64:67], v[216:219], v[56:59], v[64:67]
    ds_read_b64_tr_b16 v[254:255], v27 offset:12288
    v_exp_f32 v88, v88
    v_mfma_f32_16x16x32_bf16 v[72:75], v[216:219], v[60:63], v[72:75]
    ds_read_b128 v[212:215], v18 offset:12288
    v_exp_f32 v89, v89
    v_mfma_f32_16x16x32_bf16 v[68:71], v[220:223], v[56:59], v[68:71]
    v_exp_f32 v90, v90
    v_xor_b32 v24, 128, v20
    v_mfma_f32_16x16x32_bf16 v[76:79], v[220:223], v[60:63], v[76:79]
    ds_read_b128 v[216:219], v19 offset:8192
    v_exp_f32 v91, v91
    v_mfma_f32_16x16x32_bf16 v[128:131], v[224:227], v[96:99], v[128:131]
    v_exp_f32 v92, v92
    v_xor_b32 v25, 160, v20
    v_mfma_f32_16x16x32_bf16 v[136:139], v[228:231], v[96:99], v[136:139]
    ds_read_b128 v[220:223], v19 offset:12288
    v_exp_f32 v93, v93
    v_mfma_f32_16x16x32_bf16 v[144:147], v[232:235], v[96:99], v[144:147]
    v_exp_f32 v94, v94
    v_add_u32 v16, s72, v29
    v_mfma_f32_16x16x32_bf16 v[152:155], v[236:239], v[96:99], v[152:155]
    v_exp_f32 v95, v95
    s_waitcnt lgkmcnt(3)
    v_mfma_f32_16x16x32_bf16 v[160:163], v[240:243], v[96:99], v[160:163]
    v_cvt_pk_bf16_f32 v100, v88, v89
    v_cvt_pk_bf16_f32 v101, v90, v91
    v_mfma_f32_16x16x32_bf16 v[168:171], v[244:247], v[96:99], v[168:171]
    v_cvt_pk_bf16_f32 v102, v92, v93
    v_cvt_pk_bf16_f32 v103, v94, v95
    v_mfma_f32_16x16x32_bf16 v[176:179], v[248:251], v[96:99], v[176:179]
    v_max3_f32 v14, v64, v65, v66
    v_xor_b32 v26, 192, v20
    v_mfma_f32_16x16x32_bf16 v[184:187], v[252:255], v[96:99], v[184:187]
    v_max3_f32 v15, v67, v72, v73
    v_xor_b32 v27, 224, v20
    v_mfma_f32_16x16x32_bf16 v[104:107], v[124:127], v[96:99], v[104:107]
    s_waitcnt lgkmcnt(0)
    s_barrier
    v_mfma_f32_16x16x32_bf16 v[132:135], v[224:227], v[100:103], v[132:135]
    ds_read_b64_tr_b16 v[224:225], v20 offset:0
    v_max3_f32 v14, v14, v74, v75
    v_mfma_f32_16x16x32_bf16 v[140:143], v[228:231], v[100:103], v[140:143]
    ds_read_b64_tr_b16 v[226:227], v20 offset:4096
    v_max3_f32 v15, v15, v68, v69
    v_mfma_f32_16x16x32_bf16 v[148:151], v[232:235], v[100:103], v[148:151]
    ds_read_b64_tr_b16 v[228:229], v21 offset:0
    v_max3_f32 v14, v14, v70, v71
    v_mfma_f32_16x16x32_bf16 v[156:159], v[236:239], v[100:103], v[156:159]
    ds_read_b64_tr_b16 v[230:231], v21 offset:4096
    v_max3_f32 v15, v15, v76, v77
    v_mfma_f32_16x16x32_bf16 v[164:167], v[240:243], v[100:103], v[164:167]
    ds_read_b64_tr_b16 v[232:233], v22 offset:0
    v_max3_f32 v14, v14, v78, v79
    v_mfma_f32_16x16x32_bf16 v[172:175], v[244:247], v[100:103], v[172:175]
    ds_read_b64_tr_b16 v[234:235], v22 offset:4096
    v_max_f32 v14, v14, v15
    v_xor_b32 v19, 192, v16
    v_mfma_f32_16x16x32_bf16 v[180:183], v[248:251], v[100:103], v[180:183]
    ds_read_b64_tr_b16 v[236:237], v23 offset:0
    v_cmp_lt_f32 vcc, s74, v14
    v_mfma_f32_16x16x32_bf16 v[188:191], v[252:255], v[100:103], v[188:191]
    ds_read_b64_tr_b16 v[238:239], v23 offset:4096
    v_xor_b32 v17, 64, v16
    v_mfma_f32_16x16x32_bf16 v[108:111], v[124:127], v[100:103], v[108:111]
    ds_read_b64_tr_b16 v[240:241], v24 offset:0
    v_xor_b32 v18, 128, v16
    s_cbranch_vccnz L_slowB
L_backB:
    s_cbranch_scc0 L_loop
L_last:
L_tail:
    v_mfma_f32_16x16x32_bf16 v[80:83], v[192:195], v[32:35], v[112:115]
    ds_read_b64_tr_b16 v[242:243], v24 offset:4096
    v_exp_f32 v64, v64
    v_mfma_f32_16x16x32_bf16 v[88:91], v[192:195], v[36:39], v[116:119]
    v_exp_f32 v65, v65
    v_mfma_f32_16x16x32_bf16 v[84:87], v[196:199], v[32:35], v[112:115]
    ds_read_b64_tr_b16 v[244:245], v25 offset:0
    v_exp_f32 v66, v66
    v_mfma_f32_16x16x32_bf16 v[92:95], v[196:199], v[36:39], v[116:119]
    v_exp_f32 v67, v67
    v_xor_b32 v16, 2048, v11
    v_mfma_f32_16x16x32_bf16 v[80:83], v[200:203], v[40:43], v[80:83]
    ds_read_b64_tr_b16 v[246:247], v25 offset:4096
    v_exp_f32 v68, v68
    v_mfma_f32_16x16x32_bf16 v[88:91], v[200:203], v[44:47], v[88:91]
    v_exp_f32 v69, v69
    v_xor_b32 v17, 4096, v11
    v_mfma_f32_16x16x32_bf16 v[84:87], v[204:207], v[40:43], v[84:87]
    ds_read_b64_tr_b16 v[248:249], v26 offset:0
    v_exp_f32 v70, v70
    v_mfma_f32_16x16x32_bf16 v[92:95], v[204:207], v[44:47], v[92:95]
    s_waitcnt lgkmcnt(4)
    v_exp_f32 v71, v71
    v_mfma_f32_16x16x32_bf16 v[80:83], v[208:211], v[48:51], v[80:83]
    ds_read_b64_tr_b16 v[250:251], v26 offset:4096
    v_cvt_pk_bf16_f32 v96, v64, v65
    v_xor_b32 v18, 6144, v11
    v_mfma_f32_16x16x32_bf16 v[88:91], v[208:211], v[52:55], v[88:91]
    v_cvt_pk_bf16_f32 v97, v66, v67
    v_mov_b32 v112, v28
    v_mfma_f32_16x16x32_bf16 v[84:87], v[212:215], v[48:51], v[84:87]
    ds_read_b64_tr_b16 v[252:253], v27 offset:0
    v_cvt_pk_bf16_f32 v98, v68, v69
    v_mfma_f32_16x16x32_bf16 v[92:95], v[212:215], v[52:55], v[92:95]
    v_cvt_pk_bf16_f32 v99, v70, v71
    v_add_u32 v113, 7168 + 8192, v28
    v_mfma_f32_16x16x32_bf16 v[80:83], v[216:219], v[56:59], v[80:83]
    ds_read_b64_tr_b16 v[254:255], v27 offset:4096
    v_exp_f32 v72, v72
    v_mfma_f32_16x16x32_bf16 v[88:91], v[216:219], v[60:63], v[88:91]
    v_exp_f32 v73, v73
    v_mov_b32 v114, v12
    v_mfma_f32_16x16x32_bf16 v[84:87], v[220:223], v[56:59], v[84:87]
    v_exp_f32 v74, v74
    v_xor_b32 v115, 64, v114
    v_mfma_f32_16x16x32_bf16 v[92:95], v[220:223], v[60:63], v[92:95]
    v_exp_f32 v75, v75
    v_add_u32 v116, 65536, v114
    v_mfma_f32_16x16x32_bf16 v[128:131], v[224:227], v[96:99], v[128:131]
    v_exp_f32 v76, v76
    v_add_u32 v117, 65536, v115
    v_mfma_f32_16x16x32_bf16 v[136:139], v[228:231], v[96:99], v[136:139]
    v_exp_f32 v77, v77
    v_add_u32 v118, 131072, v114
    v_mfma_f32_16x16x32_bf16 v[144:147], v[232:235], v[96:99], v[144:147]
    v_exp_f32 v78, v78
    v_add_u32 v119, 131072, v115
    v_mfma_f32_16x16x32_bf16 v[152:155], v[236:239], v[96:99], v[152:155]
    v_exp_f32 v79, v79
    s_waitcnt lgkmcnt(0)
    v_mfma_f32_16x16x32_bf16 v[160:163], v[240:243], v[96:99], v[160:163]
    v_cvt_pk_bf16_f32 v100, v72, v73
    v_cvt_pk_bf16_f32 v101, v74, v75
    v_mfma_f32_16x16x32_bf16 v[168:171], v[244:247], v[96:99], v[168:171]
    v_cvt_pk_bf16_f32 v102, v76, v77
    v_cvt_pk_bf16_f32 v103, v78, v79
    v_mfma_f32_16x16x32_bf16 v[176:179], v[248:251], v[96:99], v[176:179]
    v_max3_f32 v14, v80, v81, v82
    v_add_u32 v120, 49152, v4
    v_mfma_f32_16x16x32_bf16 v[184:187], v[252:255], v[96:99], v[184:187]
    v_max3_f32 v15, v83, v88, v89
    v_mfma_f32_16x16x32_bf16 v[104:107], v[124:127], v[96:99], v[104:107]
    v_mfma_f32_16x16x32_bf16 v[132:135], v[224:227], v[100:103], v[132:135]
    ds_read_b64_tr_b16 v[224:225], v20 offset:8192
    v_max3_f32 v14, v14, v90, v91
    v_mfma_f32_16x16x32_bf16 v[140:143], v[228:231], v[100:103], v[140:143]
    ds_read_b64_tr_b16 v[226:227], v20 offset:12288
    v_max3_f32 v15, v15, v84, v85
    v_mfma_f32_16x16x32_bf16 v[148:151], v[232:235], v[100:103], v[148:151]
    ds_read_b64_tr_b16 v[228:229], v21 offset:8192
    v_max3_f32 v14, v14, v86, v87
    v_mfma_f32_16x16x32_bf16 v[156:159], v[236:239], v[100:103], v[156:159]
    ds_read_b64_tr_b16 v[230:231], v21 offset:12288
    v_max3_f32 v15, v15, v92, v93
    v_mfma_f32_16x16x32_bf16 v[164:167], v[240:243], v[100:103], v[164:167]
    ds_read_b64_tr_b16 v[232:233], v22 offset:8192
    v_max3_f32 v14, v14, v94, v95
    v_mfma_f32_16x16x32_bf16 v[172:175], v[244:247], v[100:103], v[172:175]
    ds_read_b64_tr_b16 v[234:235], v22 offset:12288
    v_max_f32 v14, v14, v15
    v_mfma_f32_16x16x32_bf16 v[180:183], v[248:251], v[100:103], v[180:183]
    ds_read_b64_tr_b16 v[236:237], v23 offset:8192
    v_cmp_lt_f32 vcc, s74, v14
    v_mfma_f32_16x16x32_bf16 v[188:191], v[252:255], v[100:103], v[188:191]
    ds_read_b64_tr_b16 v[238:239], v23 offset:12288
    v_mfma_f32_16x16x32_bf16 v[108:111], v[124:127], v[100:103], v[108:111]
    ds_read_b64_tr_b16 v[240:241], v24 offset:8192
    s_cbranch_vccnz L_slowC
L_backC:
    v_exp_f32 v80, v80
    ds_read_b64_tr_b16 v[242:243], v24 offset:12288
    v_exp_f32 v81, v81
    ds_read_b64_tr_b16 v[244:245], v25 offset:8192
    v_exp_f32 v82, v82
    ds_read_b64_tr_b16 v[246:247], v25 offset:12288
    v_exp_f32 v83, v83
    ds_read_b64_tr_b16 v[248:249], v26 offset:8192
    v_exp_f32 v84, v84
    ds_read_b64_tr_b16 v[250:251], v26 offset:12288
    v_exp_f32 v85, v85
    ds_read_b64_tr_b16 v[252:253], v27 offset:8192
    s_waitcnt lgkmcnt(6)
    v_exp_f32 v86, v86
    ds_read_b64_tr_b16 v[254:255], v27 offset:12288
    v_exp_f32 v87, v87
    v_cvt_pk_bf16_f32 v96, v80, v81
    v_cvt_pk_bf16_f32 v97, v82, v83
    v_cvt_pk_bf16_f32 v98, v84, v85
    v_cvt_pk_bf16_f32 v99, v86, v87
    v_exp_f32 v88, v88
    v_exp_f32 v89, v89
    v_mfma_f32_16x16x32_bf16 v[104:107], v[124:127], v[96:99], v[104:107]
    v_mfma_f32_16x16x32_bf16 v[128:131], v[224:227], v[96:99], v[128:131]
    v_exp_f32 v90, v90
    v_mfma_f32_16x16x32_bf16 v[136:139], v[228:231], v[96:99], v[136:139]
    v_exp_f32 v91, v91
    v_mfma_f32_16x16x32_bf16 v[144:147], v[232:235], v[96:99], v[144:147]
    v_exp_f32 v92, v92
    v_mfma_f32_16x16x32_bf16 v[152:155], v[236:239], v[96:99], v[152:155]
    v_exp_f32 v93, v93
    s_waitcnt lgkmcnt(0)
    v_mfma_f32_16x16x32_bf16 v[160:163], v[240:243], v[96:99], v[160:163]
    v_exp_f32 v94, v94
    v_mfma_f32_16x16x32_bf16 v[168:171], v[244:247], v[96:99], v[168:171]
    v_exp_f32 v95, v95
    v_mfma_f32_16x16x32_bf16 v[176:179], v[248:251], v[96:99], v[176:179]
    v_cvt_pk_bf16_f32 v100, v88, v89
    v_cvt_pk_bf16_f32 v101, v90, v91
    v_mfma_f32_16x16x32_bf16 v[184:187], v[252:255], v[96:99], v[184:187]
    v_cvt_pk_bf16_f32 v102, v92, v93
    v_cvt_pk_bf16_f32 v103, v94, v95
    v_rcp_f32 v14, v104
    s_nop 0
    v_mfma_f32_16x16x32_bf16 v[108:111], v[124:127], v[100:103], v[108:111]
    v_mfma_f32_16x16x32_bf16 v[132:135], v[224:227], v[100:103], v[132:135]
    v_pk_mul_f32 v[128:129], v[128:129], v[14:15] op_sel_hi:[1,0]
    v_pk_mul_f32 v[130:131], v[130:131], v[14:15] op_sel_hi:[1,0]
    v_pk_mul_f32 v[136:137], v[136:137], v[14:15] op_sel_hi:[1,0]
    v_pk_mul_f32 v[138:139], v[138:139], v[14:15] op_sel_hi:[1,0]
    v_mfma_f32_16x16x32_bf16 v[140:143], v[228:231], v[100:103], v[140:143]
    v_cvt_pk_bf16_f32 v64, v128, v129
    v_cvt_pk_bf16_f32 v65, v130, v131
    v_cvt_pk_bf16_f32 v66, v136, v137
    v_cvt_pk_bf16_f32 v67, v138, v139
    v_mfma_f32_16x16x32_bf16 v[148:151], v[232:235], v[100:103], v[148:151]
    ds_write_b128 v11, v[64:67] offset:49152
    v_pk_mul_f32 v[144:145], v[144:145], v[14:15] op_sel_hi:[1,0]
    v_pk_mul_f32 v[146:147], v[146:147], v[14:15] op_sel_hi:[1,0]
    v_pk_mul_f32 v[152:153], v[152:153], v[14:15] op_sel_hi:[1,0]
    v_mfma_f32_16x16x32_bf16 v[156:159], v[236:239], v[100:103], v[156:159]
    v_pk_mul_f32 v[154:155], v[154:155], v[14:15] op_sel_hi:[1,0]
    v_cvt_pk_bf16_f32 v72, v144, v145
    v_cvt_pk_bf16_f32 v73, v146, v147
    v_cvt_pk_bf16_f32 v74, v152, v153
    v_mfma_f32_16x16x32_bf16 v[164:167], v[240:243], v[100:103], v[164:167]
    v_rcp_f32 v6, v108
    v_cvt_pk_bf16_f32 v75, v154, v155
    ds_write_b128 v16, v[72:75] offset:49152
    v_pk_mul_f32 v[160:161], v[160:161], v[14:15] op_sel_hi:[1,0]
    v_pk_mul_f32 v[162:163], v[162:163], v[14:15] op_sel_hi:[1,0]
    v_mfma_f32_16x16x32_bf16 v[172:175], v[244:247], v[100:103], v[172:175]
    v_pk_mul_f32 v[168:169], v[168:169], v[14:15] op_sel_hi:[1,0]
    v_pk_mul_f32 v[170:171], v[170:171], v[14:15] op_sel_hi:[1,0]
    v_cvt_pk_bf16_f32 v80, v160, v161
    v_cvt_pk_bf16_f32 v81, v162, v163
    v_mfma_f32_16x16x32_bf16 v[180:183], v[248:251], v[100:103], v[180:183]
    v_cvt_pk_bf16_f32 v82, v168, v169
    v_cvt_pk_bf16_f32 v83, v170, v171
    ds_write_b128 v17, v[80:83] offset:49152
    v_pk_mul_f32 v[176:177], v[176:177], v[14:15] op_sel_hi:[1,0]
    v_mfma_f32_16x16x32_bf16 v[188:191], v[252:255], v[100:103], v[188:191]
    v_pk_mul_f32 v[178:179], v[178:179], v[14:15] op_sel_hi:[1,0]
    v_pk_mul_f32 v[184:185], v[184:185], v[14:15] op_sel_hi:[1,0]
    v_pk_mul_f32 v[186:187], v[186:187], v[14:15] op_sel_hi:[1,0]
    v_cvt_pk_bf16_f32 v88, v176, v177
    v_cvt_pk_bf16_f32 v89, v178, v179
    v_cvt_pk_bf16_f32 v90, v184, v185
    v_cvt_pk_bf16_f32 v91, v186, v187
    ds_write_b128 v18, v[88:91] offset:49152
    v_pk_mul_f32 v[132:133], v[132:133], v[6:7] op_sel_hi:[1,0]
    v_pk_mul_f32 v[134:135], v[134:135], v[6:7] op_sel_hi:[1,0]
    v_pk_mul_f32 v[140:141], v[140:141], v[6:7] op_sel_hi:[1,0]
    v_pk_mul_f32 v[142:143], v[142:143], v[6:7] op_sel_hi:[1,0]
    v_cvt_pk_bf16_f32 v68, v132, v133
    v_cvt_pk_bf16_f32 v69, v134, v135
    v_cvt_pk_bf16_f32 v70, v140, v141
    v_cvt_pk_bf16_f32 v71, v142, v143
    ds_write_b128 v11, v[68:71] offset:49408
    v_pk_mul_f32 v[148:149], v[148:149], v[6:7] op_sel_hi:[1,0]
    v_pk_mul_f32 v[150:151], v[150:151], v[6:7] op_sel_hi:[1,0]
    v_pk_mul_f32 v[156:157], v[156:157], v[6:7] op_sel_hi:[1,0]
    v_pk_mul_f32 v[158:159], v[158:159], v[6:7] op_sel_hi:[1,0]
    v_cvt_pk_bf16_f32 v76, v148, v149
    v_cvt_pk_bf16_f32 v77, v150, v151
    v_cvt_pk_bf16_f32 v78, v156, v157
    v_cvt_pk_bf16_f32 v79, v158, v159
    ds_write_b128 v16, v[76:79] offset:49408
    v_pk_mul_f32 v[164:165], v[164:165], v[6:7] op_sel_hi:[1,0]
    v_pk_mul_f32 v[166:167], v[166:167], v[6:7] op_sel_hi:[1,0]
    v_pk_mul_f32 v[172:173], v[172:173], v[6:7] op_sel_hi:[1,0]
    v_pk_mul_f32 v[174:175], v[174:175], v[6:7] op_sel_hi:[1,0]
    v_cvt_pk_bf16_f32 v84, v164, v165
    v_cvt_pk_bf16_f32 v85, v166, v167
    v_cvt_pk_bf16_f32 v86, v172, v173
    v_cvt_pk_bf16_f32 v87, v174, v175
    ds_write_b128 v17, v[84:87] offset:49408
    v_pk_mul_f32 v[180:181], v[180:181], v[6:7] op_sel_hi:[1,0]
    v_pk_mul_f32 v[182:183], v[182:183], v[6:7] op_sel_hi:[1,0]
    v_pk_mul_f32 v[188:189], v[188:189], v[6:7] op_sel_hi:[1,0]
    v_pk_mul_f32 v[190:191], v[190:191], v[6:7] op_sel_hi:[1,0]
    v_cvt_pk_bf16_f32 v92, v180, v181
    v_cvt_pk_bf16_f32 v93, v182, v183
    v_cvt_pk_bf16_f32 v94, v188, v189
    v_cvt_pk_bf16_f32 v95, v190, v191
    ds_write_b128 v18, v[92:95] offset:49408
    s_mov_b32 s77, 0
    s_waitcnt vmcnt(0)
L_chk:
    v_cmp_gt_u32 vcc, 8, v5
    s_cbranch_vccz L_chkd
    s_add_u32 s77, s77, 1
    s_cmp_gt_u32 s77, 0x40000
    s_cbranch_scc1 L_chkd
    buffer_load_dword v5, v30, s[64:67], 0 offen sc1
    s_waitcnt vmcnt(0)
    s_branch L_chk
L_chkd:
    s_waitcnt lgkmcnt(0)
    s_barrier
    s_add_u32 m0, s84, 81920
    s_xor_b32 s71, s87, 106496
    ds_read_b128 v[48:51], v120 offset:0
    ds_read_b64_tr_b16 v[32:33], v118 offset:0
    ds_read_b64_tr_b16 v[34:35], v118 offset:1024
    ds_read_b64_tr_b16 v[36:37], v119 offset:0
    ds_read_b64_tr_b16 v[38:39], v119 offset:1024
    buffer_load_dwordx4 v112, s[52:55], s71 offen offset:0 lds
    buffer_load_dwordx4 v113, s[52:55], s71 offen offset:1024 lds
    ds_read_b128 v[52:55], v120 offset:1024
    ds_read_b64_tr_b16 v[40:41], v118 offset:16384
    ds_read_b64_tr_b16 v[42:43], v118 offset:17408
    ds_read_b64_tr_b16 v[44:45], v119 offset:16384
    ds_read_b64_tr_b16 v[46:47], v119 offset:17408
    ds_read_b128 v[56:59], v120 offset:2048
    ds_read_b64_tr_b16 v[96:97], v116 offset:32768
    ds_read_b64_tr_b16 v[98:99], v116 offset:33792
    ds_read_b64_tr_b16 v[100:101], v117 offset:32768
    ds_read_b64_tr_b16 v[102:103], v117 offset:33792
    s_add_u32 m0, s84, 131072
    s_xor_b32 s71, s87, 131072
    s_waitcnt lgkmcnt(10)
    v_mfma_f32_32x32x16_bf16 v[64:79], v[32:35], v[48:51], 0
    buffer_load_dwordx4 v112, s[52:55], s71 offen offset:0 lds
    v_mfma_f32_32x32x16_bf16 v[80:95], v[36:39], v[48:51], 0
    buffer_load_dwordx4 v113, s[52:55], s71 offen offset:1024 lds
    ds_read_b128 v[60:63], v120 offset:3072
    ds_read_b64_tr_b16 v[32:33], v116 offset:49152
    ds_read_b64_tr_b16 v[34:35], v116 offset:50176
    ds_read_b64_tr_b16 v[36:37], v117 offset:49152
    ds_read_b64_tr_b16 v[38:39], v117 offset:50176
    s_add_u32 m0, s84, 147456
    s_xor_b32 s71, s87, 139264
    s_waitcnt lgkmcnt(10)
    v_mfma_f32_32x32x16_bf16 v[64:79], v[40:43], v[52:55], v[64:79]
    buffer_load_dwordx4 v112, s[52:55], s71 offen offset:0 lds
    v_mfma_f32_32x32x16_bf16 v[80:95], v[44:47], v[52:55], v[80:95]
    buffer_load_dwordx4 v113, s[52:55], s71 offen offset:1024 lds
    ds_read_b128 v[48:51], v120 offset:4096
    ds_read_b64_tr_b16 v[40:41], v114 offset:0
    ds_read_b64_tr_b16 v[42:43], v114 offset:1024
    ds_read_b64_tr_b16 v[44:45], v115 offset:0
    ds_read_b64_tr_b16 v[46:47], v115 offset:1024
    s_add_u32 m0, s84, 98304
    s_xor_b32 s71, s87, 163840
    s_waitcnt lgkmcnt(10)
    v_mfma_f32_32x32x16_bf16 v[64:79], v[96:99], v[56:59], v[64:79]
    buffer_load_dwordx4 v112, s[52:55], s71 offen offset:0 lds
    v_mfma_f32_32x32x16_bf16 v[80:95], v[100:103], v[56:59], v[80:95]
    buffer_load_dwordx4 v113, s[52:55], s71 offen offset:1024 lds
    ds_read_b128 v[52:55], v120 offset:5120
    ds_read_b64_tr_b16 v[96:97], v114 offset:16384
    ds_read_b64_tr_b16 v[98:99], v114 offset:17408
    ds_read_b64_tr_b16 v[100:101], v115 offset:16384
    ds_read_b64_tr_b16 v[102:103], v115 offset:17408
    s_add_u32 m0, s84, 114688
    s_xor_b32 s71, s87, 172032
    s_waitcnt lgkmcnt(10)
    v_mfma_f32_32x32x16_bf16 v[64:79], v[32:35], v[60:63], v[64:79]
    buffer_load_dwordx4 v112, s[52:55], s71 offen offset:0 lds
    v_mfma_f32_32x32x16_bf16 v[80:95], v[36:39], v[60:63], v[80:95]
    buffer_load_dwordx4 v113, s[52:55], s71 offen offset:1024 lds
    ds_read_b128 v[56:59], v120 offset:6144
    ds_read_b64_tr_b16 v[32:33], v114 offset:32768
    ds_read_b64_tr_b16 v[34:35], v114 offset:33792
    ds_read_b64_tr_b16 v[36:37], v115 offset:32768
    ds_read_b64_tr_b16 v[38:39], v115 offset:33792
    s_add_u32 m0, s84, 0
    s_xor_b32 s71, s87, 196608
    s_waitcnt lgkmcnt(10)
    v_mfma_f32_32x32x16_bf16 v[64:79], v[40:43], v[48:51], v[64:79]
    buffer_load_dwordx4 v112, s[52:55], s71 offen offset:0 lds
    v_mfma_f32_32x32x16_bf16 v[80:95], v[44:47], v[48:51], v[80:95]
    buffer_load_dwordx4 v113, s[52:55], s71 offen offset:1024 lds
    s_waitcnt vmcnt(10)
    ds_read_b128 v[60:63], v120 offset:7168
    ds_read_b64_tr_b16 v[40:41], v116 offset:16384
    ds_read_b64_tr_b16 v[42:43], v116 offset:17408
    ds_read_b64_tr_b16 v[44:45], v117 offset:16384
    ds_read_b64_tr_b16 v[46:47], v117 offset:17408
    s_add_u32 m0, s84, 16384
    s_xor_b32 s71, s87, 204800
    s_waitcnt lgkmcnt(10)
    v_mfma_f32_32x32x16_bf16 v[64:79], v[96:99], v[52:55], v[64:79]
    buffer_load_dwordx4 v112, s[52:55], s71 offen offset:0 lds
    v_mfma_f32_32x32x16_bf16 v[80:95], v[100:103], v[52:55], v[80:95]
    buffer_load_dwordx4 v113, s[52:55], s71 offen offset:1024 lds
    s_waitcnt vmcnt(10)
    ds_read_b128 v[48:51], v120 offset:8192
    ds_read_b64_tr_b16 v[96:97], v118 offset:0
    ds_read_b64_tr_b16 v[98:99], v118 offset:1024
    ds_read_b64_tr_b16 v[100:101], v119 offset:0
    ds_read_b64_tr_b16 v[102:103], v119 offset:1024
    s_add_u32 m0, s84, 32768
    s_xor_b32 s71, s87, 229376
    s_waitcnt lgkmcnt(10)
    v_mfma_f32_32x32x16_bf16 v[64:79], v[32:35], v[56:59], v[64:79]
    buffer_load_dwordx4 v112, s[52:55], s71 offen offset:0 lds
    v_mfma_f32_32x32x16_bf16 v[80:95], v[36:39], v[56:59], v[80:95]
    buffer_load_dwordx4 v113, s[52:55], s71 offen offset:1024 lds
    s_waitcnt vmcnt(10)
    ds_read_b128 v[52:55], v120 offset:9216
    ds_read_b64_tr_b16 v[32:33], v118 offset:16384
    ds_read_b64_tr_b16 v[34:35], v118 offset:17408
    ds_read_b64_tr_b16 v[36:37], v119 offset:16384
    ds_read_b64_tr_b16 v[38:39], v119 offset:17408
    s_add_u32 m0, s84, 81920
    s_xor_b32 s71, s87, 237568
    s_waitcnt lgkmcnt(10)
    v_mfma_f32_32x32x16_bf16 v[64:79], v[40:43], v[60:63], v[64:79]
    buffer_load_dwordx4 v112, s[52:55], s71 offen offset:0 lds
    v_mfma_f32_32x32x16_bf16 v[80:95], v[44:47], v[60:63], v[80:95]
    buffer_load_dwordx4 v113, s[52:55], s71 offen offset:1024 lds
    s_waitcnt vmcnt(10)
    ds_read_b128 v[56:59], v120 offset:10240
    ds_read_b64_tr_b16 v[40:41], v116 offset:32768
    ds_read_b64_tr_b16 v[42:43], v116 offset:33792
    ds_read_b64_tr_b16 v[44:45], v117 offset:32768
    ds_read_b64_tr_b16 v[46:47], v117 offset:33792
    s_add_u32 m0, s84, 131072
    s_xor_b32 s71, s87, 262144
    s_waitcnt lgkmcnt(10)
    v_mfma_f32_32x32x16_bf16 v[64:79], v[96:99], v[48:51], v[64:79]
    buffer_load_dwordx4 v112, s[52:55], s71 offen offset:0 lds
    v_mfma_f32_32x32x16_bf16 v[80:95], v[100:103], v[48:51], v[80:95]
    buffer_load_dwordx4 v113, s[52:55], s71 offen offset:1024 lds
    s_waitcnt vmcnt(10)
    ds_read_b128 v[60:63], v120 offset:11264
    ds_read_b64_tr_b16 v[96:97], v116 offset:49152
    ds_read_b64_tr_b16 v[98:99], v116 offset:50176
    ds_read_b64_tr_b16 v[100:101], v117 offset:49152
    ds_read_b64_tr_b16 v[102:103], v117 offset:50176
    s_add_u32 m0, s84, 147456
    s_xor_b32 s71, s87, 270336
    s_waitcnt lgkmcnt(10)
    v_mfma_f32_32x32x16_bf16 v[64:79], v[32:35], v[52:55], v[64:79]
    buffer_load_dwordx4 v112, s[52:55], s71 offen offset:0 lds
    v_mfma_f32_32x32x16_bf16 v[80:95], v[36:39], v[52:55], v[80:95]
    buffer_load_dwordx4 v113, s[52:55], s71 offen offset:1024 lds
    s_waitcnt vmcnt(10)
    ds_read_b128 v[48:51], v120 offset:12288
    ds_read_b64_tr_b16 v[32:33], v114 offset:0
    ds_read_b64_tr_b16 v[34:35], v114 offset:1024
    ds_read_b64_tr_b16 v[36:37], v115 offset:0
    ds_read_b64_tr_b16 v[38:39], v115 offset:1024
    s_add_u32 m0, s84, 98304
    s_xor_b32 s71, s87, 294912
    s_waitcnt lgkmcnt(10)
    v_mfma_f32_32x32x16_bf16 v[64:79], v[40:43], v[56:59], v[64:79]
    buffer_load_dwordx4 v112, s[52:55], s71 offen offset:0 lds
    v_mfma_f32_32x32x16_bf16 v[80:95], v[44:47], v[56:59], v[80:95]
    buffer_load_dwordx4 v113, s[52:55], s71 offen offset:1024 lds
    s_waitcnt vmcnt(10)
    ds_read_b128 v[52:55], v120 offset:13312
    ds_read_b64_tr_b16 v[40:41], v114 offset:16384
    ds_read_b64_tr_b16 v[42:43], v114 offset:17408
    ds_read_b64_tr_b16 v[44:45], v115 offset:16384
    ds_read_b64_tr_b16 v[46:47], v115 offset:17408
    s_add_u32 m0, s84, 114688
    s_xor_b32 s71, s87, 303104
    s_waitcnt lgkmcnt(10)
    v_mfma_f32_32x32x16_bf16 v[64:79], v[96:99], v[60:63], v[64:79]
    buffer_load_dwordx4 v112, s[52:55], s71 offen offset:0 lds
    v_mfma_f32_32x32x16_bf16 v[80:95], v[100:103], v[60:63], v[80:95]
    buffer_load_dwordx4 v113, s[52:55], s71 offen offset:1024 lds
    s_waitcnt vmcnt(10)
    ds_read_b128 v[56:59], v120 offset:14336
    ds_read_b64_tr_b16 v[96:97], v114 offset:32768
    ds_read_b64_tr_b16 v[98:99], v114 offset:33792
    ds_read_b64_tr_b16 v[100:101], v115 offset:32768
    ds_read_b64_tr_b16 v[102:103], v115 offset:33792
    s_add_u32 m0, s84, 0
    s_xor_b32 s71, s87, 327680
    s_waitcnt lgkmcnt(10)
    v_mfma_f32_32x32x16_bf16 v[64:79], v[32:35], v[48:51], v[64:79]
    buffer_load_dwordx4 v112, s[52:55], s71 offen offset:0 lds
    v_mfma_f32_32x32x16_bf16 v[80:95], v[36:39], v[48:51], v[80:95]
    buffer_load_dwordx4 v113, s[52:55], s71 offen offset:1024 lds
    s_waitcnt vmcnt(10)
    ds_read_b128 v[60:63], v120 offset:15360
    ds_read_b64_tr_b16 v[32:33], v116 offset:16384
    ds_read_b64_tr_b16 v[34:35], v116 offset:17408
    ds_read_b64_tr_b16 v[36:37], v117 offset:16384
    ds_read_b64_tr_b16 v[38:39], v117 offset:17408
    s_add_u32 m0, s84, 16384
    s_xor_b32 s71, s87, 335872
    s_waitcnt lgkmcnt(10)
    v_mfma_f32_32x32x16_bf16 v[64:79], v[40:43], v[52:55], v[64:79]
    buffer_load_dwordx4 v112, s[52:55], s71 offen offset:0 lds
    v_mfma_f32_32x32x16_bf16 v[80:95], v[44:47], v[52:55], v[80:95]
    buffer_load_dwordx4 v113, s[52:55], s71 offen offset:1024 lds
    s_waitcnt vmcnt(10)
    ds_read_b128 v[48:51], v120 offset:16384
    ds_read_b64_tr_b16 v[40:41], v118 offset:0
    ds_read_b64_tr_b16 v[42:43], v118 offset:1024
    ds_read_b64_tr_b16 v[44:45], v119 offset:0
    ds_read_b64_tr_b16 v[46:47], v119 offset:1024
    s_add_u32 m0, s84, 32768
    s_xor_b32 s71, s87, 360448
    s_waitcnt lgkmcnt(10)
    v_mfma_f32_32x32x16_bf16 v[64:79], v[96:99], v[56:59], v[64:79]
    buffer_load_dwordx4 v112, s[52:55], s71 offen offset:0 lds
    v_mfma_f32_32x32x16_bf16 v[80:95], v[100:103], v[56:59], v[80:95]
    buffer_load_dwordx4 v113, s[52:55], s71 offen offset:1024 lds
    s_waitcnt vmcnt(10)
    ds_read_b128 v[52:55], v120 offset:17408
    ds_read_b64_tr_b16 v[96:97], v118 offset:16384
    ds_read_b64_tr_b16 v[98:99], v118 offset:17408
    ds_read_b64_tr_b16 v[100:101], v119 offset:16384
    ds_read_b64_tr_b16 v[102:103], v119 offset:17408
    s_add_u32 m0, s84, 81920
    s_xor_b32 s71, s87, 368640
    s_waitcnt lgkmcnt(10)
    v_mfma_f32_32x32x16_bf16 v[64:79], v[32:35], v[60:63], v[64:79]
    buffer_load_dwordx4 v112, s[52:55], s71 offen offset:0 lds
    v_mfma_f32_32x32x16_bf16 v[80:95], v[36:39], v[60:63], v[80:95]
    buffer_load_dwordx4 v113, s[52:55], s71 offen offset:1024 lds
    s_waitcnt vmcnt(10)
    ds_read_b128 v[56:59], v120 offset:18432
    ds_read_b64_tr_b16 v[32:33], v116 offset:32768
    ds_read_b64_tr_b16 v[34:35], v116 offset:33792
    ds_read_b64_tr_b16 v[36:37], v117 offset:32768
    ds_read_b64_tr_b16 v[38:39], v117 offset:33792
    s_add_u32 m0, s84, 131072
    s_xor_b32 s71, s87, 393216
    s_waitcnt lgkmcnt(10)
    v_mfma_f32_32x32x16_bf16 v[64:79], v[40:43], v[48:51], v[64:79]
    buffer_load_dwordx4 v112, s[52:55], s71 offen offset:0 lds
    v_mfma_f32_32x32x16_bf16 v[80:95], v[44:47], v[48:51], v[80:95]
    buffer_load_dwordx4 v113, s[52:55], s71 offen offset:1024 lds
    s_waitcnt vmcnt(10)
    ds_read_b128 v[60:63], v120 offset:19456
    ds_read_b64_tr_b16 v[40:41], v116 offset:49152
    ds_read_b64_tr_b16 v[42:43], v116 offset:50176
    ds_read_b64_tr_b16 v[44:45], v117 offset:49152
    ds_read_b64_tr_b16 v[46:47], v117 offset:50176
    s_add_u32 m0, s84, 147456
    s_xor_b32 s71, s87, 401408
    s_waitcnt lgkmcnt(10)
    v_mfma_f32_32x32x16_bf16 v[64:79], v[96:99], v[52:55], v[64:79]
    buffer_load_dwordx4 v112, s[52:55], s71 offen offset:0 lds
    v_mfma_f32_32x32x16_bf16 v[80:95], v[100:103], v[52:55], v[80:95]
    buffer_load_dwordx4 v113, s[52:55], s71 offen offset:1024 lds
    s_waitcnt vmcnt(10)
    ds_read_b128 v[48:51], v120 offset:20480
    ds_read_b64_tr_b16 v[96:97], v114 offset:0
    ds_read_b64_tr_b16 v[98:99], v114 offset:1024
    ds_read_b64_tr_b16 v[100:101], v115 offset:0
    ds_read_b64_tr_b16 v[102:103], v115 offset:1024
    s_add_u32 m0, s84, 98304
    s_xor_b32 s71, s87, 425984
    s_waitcnt lgkmcnt(10)
    v_mfma_f32_32x32x16_bf16 v[64:79], v[32:35], v[56:59], v[64:79]
    buffer_load_dwordx4 v112, s[52:55], s71 offen offset:0 lds
    v_mfma_f32_32x32x16_bf16 v[80:95], v[36:39], v[56:59], v[80:95]
    buffer_load_dwordx4 v113, s[52:55], s71 offen offset:1024 lds
    s_waitcnt vmcnt(10)
    ds_read_b128 v[52:55], v120 offset:21504
    ds_read_b64_tr_b16 v[32:33], v114 offset:16384
    ds_read_b64_tr_b16 v[34:35], v114 offset:17408
    ds_read_b64_tr_b16 v[36:37], v115 offset:16384
    ds_read_b64_tr_b16 v[38:39], v115 offset:17408
    s_add_u32 m0, s84, 114688
    s_xor_b32 s71, s87, 434176
    s_waitcnt lgkmcnt(10)
    v_mfma_f32_32x32x16_bf16 v[64:79], v[40:43], v[60:63], v[64:79]
    buffer_load_dwordx4 v112, s[52:55], s71 offen offset:0 lds
    v_mfma_f32_32x32x16_bf16 v[80:95], v[44:47], v[60:63], v[80:95]
    buffer_load_dwordx4 v113, s[52:55], s71 offen offset:1024 lds
    s_waitcnt vmcnt(10)
    ds_read_b128 v[56:59], v120 offset:22528
    ds_read_b64_tr_b16 v[40:41], v114 offset:32768
    ds_read_b64_tr_b16 v[42:43], v114 offset:33792
    ds_read_b64_tr_b16 v[44:45], v115 offset:32768
    ds_read_b64_tr_b16 v[46:47], v115 offset:33792
    s_add_u32 m0, s84, 0
    s_xor_b32 s71, s87, 458752
    s_waitcnt lgkmcnt(10)
    v_mfma_f32_32x32x16_bf16 v[64:79], v[96:99], v[48:51], v[64:79]
    buffer_load_dwordx4 v112, s[52:55], s71 offen offset:0 lds
    v_mfma_f32_32x32x16_bf16 v[80:95], v[100:103], v[48:51], v[80:95]
    buffer_load_dwordx4 v113, s[52:55], s71 offen offset:1024 lds
    s_waitcnt vmcnt(10)
    ds_read_b128 v[60:63], v120 offset:23552
    ds_read_b64_tr_b16 v[96:97], v116 offset:16384
    ds_read_b64_tr_b16 v[98:99], v116 offset:17408
    ds_read_b64_tr_b16 v[100:101], v117 offset:16384
    ds_read_b64_tr_b16 v[102:103], v117 offset:17408
    s_add_u32 m0, s84, 16384
    s_xor_b32 s71, s87, 466944
    s_waitcnt lgkmcnt(10)
    v_mfma_f32_32x32x16_bf16 v[64:79], v[32:35], v[52:55], v[64:79]
    buffer_load_dwordx4 v112, s[52:55], s71 offen offset:0 lds
    v_mfma_f32_32x32x16_bf16 v[80:95], v[36:39], v[52:55], v[80:95]
    buffer_load_dwordx4 v113, s[52:55], s71 offen offset:1024 lds
    s_waitcnt vmcnt(10)
    ds_read_b128 v[48:51], v120 offset:24576
    ds_read_b64_tr_b16 v[32:33], v118 offset:0
    ds_read_b64_tr_b16 v[34:35], v118 offset:1024
    ds_read_b64_tr_b16 v[36:37], v119 offset:0
    ds_read_b64_tr_b16 v[38:39], v119 offset:1024
    s_add_u32 m0, s84, 32768
    s_xor_b32 s71, s87, 491520
    s_waitcnt lgkmcnt(10)
    v_mfma_f32_32x32x16_bf16 v[64:79], v[40:43], v[56:59], v[64:79]
    buffer_load_dwordx4 v112, s[52:55], s71 offen offset:0 lds
    v_mfma_f32_32x32x16_bf16 v[80:95], v[44:47], v[56:59], v[80:95]
    buffer_load_dwordx4 v113, s[52:55], s71 offen offset:1024 lds
    s_waitcnt vmcnt(10)
    ds_read_b128 v[52:55], v120 offset:25600
    ds_read_b64_tr_b16 v[40:41], v118 offset:16384
    ds_read_b64_tr_b16 v[42:43], v118 offset:17408
    ds_read_b64_tr_b16 v[44:45], v119 offset:16384
    ds_read_b64_tr_b16 v[46:47], v119 offset:17408
    s_add_u32 m0, s84, 81920
    s_xor_b32 s71, s87, 499712
    s_waitcnt lgkmcnt(10)
    v_mfma_f32_32x32x16_bf16 v[64:79], v[96:99], v[60:63], v[64:79]
    buffer_load_dwordx4 v112, s[52:55], s71 offen offset:0 lds
    v_mfma_f32_32x32x16_bf16 v[80:95], v[100:103], v[60:63], v[80:95]
    buffer_load_dwordx4 v113, s[52:55], s71 offen offset:1024 lds
    s_waitcnt vmcnt(10)
    ds_read_b128 v[56:59], v120 offset:26624
    ds_read_b64_tr_b16 v[96:97], v116 offset:32768
    ds_read_b64_tr_b16 v[98:99], v116 offset:33792
    ds_read_b64_tr_b16 v[100:101], v117 offset:32768
    ds_read_b64_tr_b16 v[102:103], v117 offset:33792
    s_waitcnt lgkmcnt(10)
    v_mfma_f32_32x32x16_bf16 v[64:79], v[32:35], v[48:51], v[64:79]
    v_mfma_f32_32x32x16_bf16 v[80:95], v[36:39], v[48:51], v[80:95]
    s_waitcnt vmcnt(8)
    ds_read_b128 v[60:63], v120 offset:27648
    ds_read_b64_tr_b16 v[32:33], v116 offset:49152
    ds_read_b64_tr_b16 v[34:35], v116 offset:50176
    ds_read_b64_tr_b16 v[36:37], v117 offset:49152
    ds_read_b64_tr_b16 v[38:39], v117 offset:50176
    s_waitcnt lgkmcnt(10)
    v_mfma_f32_32x32x16_bf16 v[64:79], v[40:43], v[52:55], v[64:79]
    v_mfma_f32_32x32x16_bf16 v[80:95], v[44:47], v[52:55], v[80:95]
    s_waitcnt vmcnt(6)
    ds_read_b128 v[48:51], v120 offset:28672
    ds_read_b64_tr_b16 v[40:41], v114 offset:0
    ds_read_b64_tr_b16 v[42:43], v114 offset:1024
    ds_read_b64_tr_b16 v[44:45], v115 offset:0
    ds_read_b64_tr_b16 v[46:47], v115 offset:1024
    s_waitcnt lgkmcnt(10)
    v_mfma_f32_32x32x16_bf16 v[64:79], v[96:99], v[56:59], v[64:79]
    v_mfma_f32_32x32x16_bf16 v[80:95], v[100:103], v[56:59], v[80:95]
    s_waitcnt vmcnt(4)
    ds_read_b128 v[52:55], v120 offset:29696
    ds_read_b64_tr_b16 v[96:97], v114 offset:16384
    ds_read_b64_tr_b16 v[98:99], v114 offset:17408
    ds_read_b64_tr_b16 v[100:101], v115 offset:16384
    ds_read_b64_tr_b16 v[102:103], v115 offset:17408
    s_waitcnt lgkmcnt(10)
    v_mfma_f32_32x32x16_bf16 v[64:79], v[32:35], v[60:63], v[64:79]
    v_mfma_f32_32x32x16_bf16 v[80:95], v[36:39], v[60:63], v[80:95]
    s_waitcnt vmcnt(2)
    ds_read_b128 v[56:59], v120 offset:30720
    ds_read_b64_tr_b16 v[32:33], v114 offset:32768
    ds_read_b64_tr_b16 v[34:35], v114 offset:33792
    ds_read_b64_tr_b16 v[36:37], v115 offset:32768
    ds_read_b64_tr_b16 v[38:39], v115 offset:33792
    s_waitcnt lgkmcnt(10)
    v_mfma_f32_32x32x16_bf16 v[64:79], v[40:43], v[48:51], v[64:79]
    v_mfma_f32_32x32x16_bf16 v[80:95], v[44:47], v[48:51], v[80:95]
    s_waitcnt vmcnt(0)
    ds_read_b128 v[60:63], v120 offset:31744
    ds_read_b64_tr_b16 v[40:41], v116 offset:16384
    ds_read_b64_tr_b16 v[42:43], v116 offset:17408
    ds_read_b64_tr_b16 v[44:45], v117 offset:16384
    ds_read_b64_tr_b16 v[46:47], v117 offset:17408
    s_waitcnt lgkmcnt(10)
    v_mfma_f32_32x32x16_bf16 v[64:79], v[96:99], v[52:55], v[64:79]
    v_mfma_f32_32x32x16_bf16 v[80:95], v[100:103], v[52:55], v[80:95]
    s_waitcnt lgkmcnt(5)
    v_mfma_f32_32x32x16_bf16 v[64:79], v[32:35], v[56:59], v[64:79]
    v_mfma_f32_32x32x16_bf16 v[80:95], v[36:39], v[56:59], v[80:95]
    s_waitcnt lgkmcnt(0)
    v_mfma_f32_32x32x16_bf16 v[64:79], v[40:43], v[60:63], v[64:79]
    v_mfma_f32_32x32x16_bf16 v[80:95], v[44:47], v[60:63], v[80:95]
L_pubC:
    s_lshl_b32 s68, s34, 3
    s_add_u32 s69, s68, s30
    s_lshl_b32 s70, s69, 3
    s_add_u32 s70, s70, s31
    s_lshl_b32 s70, s70, 12
    s_lshl_b32 s69, s69, 7
    s_add_u32 s69, s69, 16777216
    s_lshl_b32 s74, s31, 2
    s_add_u32 s69, s69, s74
    s_add_u32 s68, s68, s31
    v_mov_b32 v10, 1
    v_mov_b32 v11, 0
    v_cvt_pk_bf16_f32 v96, v64, v65
    v_cvt_pk_bf16_f32 v97, v66, v67
    v_cvt_pk_bf16_f32 v98, v68, v69
    v_cvt_pk_bf16_f32 v99, v70, v71
    buffer_store_dwordx4 v[96:99], v4, s[56:59], s70 offen offset:0 sc1
    v_cvt_pk_bf16_f32 v100, v72, v73
    v_cvt_pk_bf16_f32 v101, v74, v75
    v_cvt_pk_bf16_f32 v102, v76, v77
    v_cvt_pk_bf16_f32 v103, v78, v79
    buffer_store_dwordx4 v[100:103], v4, s[56:59], s70 offen offset:1024 sc1
    v_cvt_pk_bf16_f32 v104, v80, v81
    v_cvt_pk_bf16_f32 v105, v82, v83
    v_cvt_pk_bf16_f32 v106, v84, v85
    v_cvt_pk_bf16_f32 v107, v86, v87
    buffer_store_dwordx4 v[104:107], v4, s[56:59], s70 offen offset:2048 sc1
    v_cvt_pk_bf16_f32 v108, v88, v89
    v_cvt_pk_bf16_f32 v109, v90, v91
    v_cvt_pk_bf16_f32 v110, v92, v93
    v_cvt_pk_bf16_f32 v111, v94, v95
    buffer_store_dwordx4 v[108:111], v4, s[56:59], s70 offen offset:3072 sc1
    v_lshlrev_b32 v12, 2, v0
    s_lshl_b32 s75, s68, 7
    s_add_u32 s75, s75, 16777216
    s_lshl_b32 s68, s68, 15
    s_lshr_b32 s74, s30, 1
    s_lshl_b32 s70, s74, 10
    s_add_u32 s68, s68, s70
    s_and_b32 s70, s30, 1
    s_lshl_b32 s71, s70, 8
    s_add_u32 s68, s68, s71
    v_bfe_u32 v14, v0, 4, 1
    v_lshlrev_b32 v15, 4, v2
    v_lshl_add_u32 v15, v14, 9, v15
    v_lshl_add_u32 v15, v3, 12, v15
    v_lshlrev_b32 v20, 11, v2
    v_lshl_add_u32 v20, v14, 4, v20
    v_lshl_add_u32 v20, v3, 3, v20
    s_lshl_b32 s74, s74, 5
    s_lshl_b32 s70, s70, 15
    s_add_u32 s74, s74, s70
    s_waitcnt vmcnt(0)
    s_mov_b64 exec, 1
    buffer_store_dword v10, v11, s[56:59], s69 offen sc1
    s_mov_b64 exec, 0xff
    s_mov_b32 s77, 0
    s_cmp_eq_u32 s30, 0
    s_cbranch_scc0 L_polledC
L_pollC:
    buffer_load_dword v13, v12, s[56:59], s75 offen sc1
    s_add_u32 s77, s77, 1
    s_cmp_gt_u32 s77, 0x40000
    s_cbranch_scc1 L_polledC
    s_waitcnt vmcnt(0)
    v_cmp_ne_u32 vcc, 1, v13
    s_cbranch_vccnz L_pollC
L_polledC:
    s_mov_b64 exec, -1
    s_barrier
    buffer_load_dwordx4 v[96:99], v15, s[56:59], s68 offen sc1
    s_add_u32 s68, s68, 8192
    buffer_load_dwordx4 v[100:103], v15, s[56:59], s68 offen sc1
    s_add_u32 s68, s68, 8192
    buffer_load_dwordx4 v[104:107], v15, s[56:59], s68 offen sc1
    s_add_u32 s68, s68, 8192
    buffer_load_dwordx4 v[108:111], v15, s[56:59], s68 offen sc1
    s_mov_b32 s69, 0xffff0000
    s_waitcnt vmcnt(3)
    v_lshlrev_b32 v64, 16, v96
    v_and_b32 v65, s69, v96
    v_lshlrev_b32 v66, 16, v97
    v_and_b32 v67, s69, v97
    v_lshlrev_b32 v68, 16, v98
    v_and_b32 v69, s69, v98
    v_lshlrev_b32 v70, 16, v99
    v_and_b32 v71, s69, v99
    s_waitcnt vmcnt(2)
    v_lshlrev_b32 v72, 16, v100
    v_and_b32 v73, s69, v100
    v_lshlrev_b32 v74, 16, v101
    v_and_b32 v75, s69, v101
    v_lshlrev_b32 v76, 16, v102
    v_and_b32 v77, s69, v102
    v_lshlrev_b32 v78, 16, v103
    v_and_b32 v79, s69, v103
    v_add_f32 v64, v64, v72
    v_add_f32 v65, v65, v73
    v_add_f32 v66, v66, v74
    v_add_f32 v67, v67, v75
    v_add_f32 v68, v68, v76
    v_add_f32 v69, v69, v77
    v_add_f32 v70, v70, v78
    v_add_f32 v71, v71, v79
    s_waitcnt vmcnt(1)
    v_lshlrev_b32 v72, 16, v104
    v_and_b32 v73, s69, v104
    v_lshlrev_b32 v74, 16, v105
    v_and_b32 v75, s69, v105
    v_lshlrev_b32 v76, 16, v106
    v_and_b32 v77, s69, v106
    v_lshlrev_b32 v78, 16, v107
    v_and_b32 v79, s69, v107
    v_add_f32 v64, v64, v72
    v_add_f32 v65, v65, v73
    v_add_f32 v66, v66, v74
    v_add_f32 v67, v67, v75
    v_add_f32 v68, v68, v76
    v_add_f32 v69, v69, v77
    v_add_f32 v70, v70, v78
    v_add_f32 v71, v71, v79
    s_waitcnt vmcnt(0)
    v_lshlrev_b32 v72, 16, v108
    v_and_b32 v73, s69, v108
    v_lshlrev_b32 v74, 16, v109
    v_and_b32 v75, s69, v109
    v_lshlrev_b32 v76, 16, v110
    v_and_b32 v77, s69, v110
    v_lshlrev_b32 v78, 16, v111
    v_and_b32 v79, s69, v111
    v_add_f32 v64, v64, v72
    v_add_f32 v65, v65, v73
    v_add_f32 v66, v66, v74
    v_add_f32 v67, v67, v75
    v_add_f32 v68, v68, v76
    v_add_f32 v69, v69, v77
    v_add_f32 v70, v70, v78
    v_add_f32 v71, v71, v79
    s_nop 0
    v_permlane32_swap_b32 v64, v68
    v_permlane32_swap_b32 v65, v69
    v_permlane32_swap_b32 v66, v70
    v_permlane32_swap_b32 v67, v71
    v_add_f32 v64, v64, v68
    v_add_f32 v65, v65, v69
    v_add_f32 v66, v66, v70
    v_add_f32 v67, v67, v71
    v_cvt_pk_bf16_f32 v96, v64, v65
    v_cvt_pk_bf16_f32 v97, v66, v67
    buffer_store_dwordx2 v[96:97], v20, s[60:63], s74 offen
    s_endpgm
L_helper:
    v_lshrrev_b32 v112, 3, v0
    v_and_b32 v113, 7, v0
    v_bfe_u32 v114, v0, 4, 1
    v_lshlrev_b32 v114, 2, v114
    v_xor_b32 v113, v113, v114
    v_lshlrev_b32 v113, 4, v113
    v_lshl_add_u32 v112, v112, 10, v113
    v_add_u32 v113, 15360, v112
    v_and_b32 v114, 1, v0
    v_bfe_u32 v115, v0, 1, 1
    v_lshlrev_b32 v114, 4, v114
    v_lshl_add_u32 v114, v115, 3, v114
    v_and_b32 v115, 1, v1
    v_lshl_add_u32 v114, v115, 5, v114
    v_lshl_add_u32 v114, v3, 9, v114
    v_bfe_u32 v115, v0, 2, 2
    v_lshl_add_u32 v114, v115, 7, v114
    v_bfe_u32 v115, v0, 3, 1
    v_lshl_add_u32 v121, v115, 6, v114
    v_add_u32 v114, s84, v121
    v_xor_b32 v115, 64, v114
    v_add_u32 v116, 65536, v114
    v_add_u32 v117, 65536, v115
    v_add_u32 v118, 131072, v114
    v_add_u32 v119, 131072, v115
    v_add_u32 v120, 49152, v4
    v_add_u32 v13, s72, v4
    v_add_u32 v11, s72, v4
    v_add_u32 v10, 131072, v11
    v_add_u32 v11, 65536, v11
    v_add_u32 v122, s72, v121
    v_add_u32 v122, 131072, v122
    v_xor_b32 v123, 64, v122
    s_waitcnt vmcnt(0)
    s_barrier
    s_barrier
    s_barrier
    s_barrier
    s_add_u32 m0, s72, 0
    s_add_u32 s68, s72, 0
    buffer_load_dwordx4 v5, s[36:39], s68 offen offset:0 nt lds
    buffer_load_dwordx4 v6, s[36:39], s68 offen offset:1024 nt lds
    buffer_load_dwordx4 v7, s[36:39], s68 offen offset:2048 nt lds
    buffer_load_dwordx4 v8, s[36:39], s68 offen offset:3072 nt lds
    s_add_u32 m0, s72, 16384
    s_add_u32 s68, s72, 0
    buffer_load_dwordx4 v9, s[40:43], s68 offen offset:0 nt lds
    buffer_load_dwordx4 v12, s[40:43], s68 offen offset:1024 nt lds
    buffer_load_dwordx4 v9, s[40:43], s68 offen offset:2048 nt lds
    buffer_load_dwordx4 v12, s[40:43], s68 offen offset:3072 nt lds
    s_add_u32 m0, s72, 32768
    s_add_u32 s68, s72, 16384
    buffer_load_dwordx4 v5, s[36:39], s68 offen offset:0 nt lds
    buffer_load_dwordx4 v6, s[36:39], s68 offen offset:1024 nt lds
    buffer_load_dwordx4 v7, s[36:39], s68 offen offset:2048 nt lds
    buffer_load_dwordx4 v8, s[36:39], s68 offen offset:3072 nt lds
    s_barrier
    s_add_u32 m0, s72, 49152
    s_add_u32 s68, s72, 16384
    buffer_load_dwordx4 v9, s[40:43], s68 offen offset:0 nt lds
    buffer_load_dwordx4 v12, s[40:43], s68 offen offset:1024 nt lds
    buffer_load_dwordx4 v9, s[40:43], s68 offen offset:2048 nt lds
    buffer_load_dwordx4 v12, s[40:43], s68 offen offset:3072 nt lds
    s_add_u32 m0, s72, 65536
    s_add_u32 s68, s72, 32768
    buffer_load_dwordx4 v5, s[36:39], s68 offen offset:0 nt lds
    buffer_load_dwordx4 v6, s[36:39], s68 offen offset:1024 nt lds
    buffer_load_dwordx4 v7, s[36:39], s68 offen offset:2048 nt lds
    buffer_load_dwordx4 v8, s[36:39], s68 offen offset:3072 nt lds
    s_waitcnt vmcnt(16)
    s_barrier
    s_add_u32 m0, s72, 81920
    s_add_u32 s68, s72, 32768
    buffer_load_dwordx4 v9, s[40:43], s68 offen offset:0 nt lds
    buffer_load_dwordx4 v12, s[40:43], s68 offen offset:1024 nt lds
    buffer_load_dwordx4 v9, s[40:43], s68 offen offset:2048 nt lds
    buffer_load_dwordx4 v12, s[40:43], s68 offen offset:3072 nt lds
    s_waitcnt vmcnt(12)
    s_barrier
    s_add_u32 m0, s72, 98304
    s_add_u32 s68, s72, 49152
    buffer_load_dwordx4 v5, s[36:39], s68 offen offset:0 nt lds
    buffer_load_dwordx4 v6, s[36:39], s68 offen offset:1024 nt lds
    buffer_load_dwordx4 v7, s[36:39], s68 offen offset:2048 nt lds
    buffer_load_dwordx4 v8, s[36:39], s68 offen offset:3072 nt lds
    s_add_u32 m0, s72, 114688
    s_add_u32 s68, s72, 49152
    buffer_load_dwordx4 v9, s[40:43], s68 offen offset:0 nt lds
    buffer_load_dwordx4 v12, s[40:43], s68 offen offset:1024 nt lds
    buffer_load_dwordx4 v9, s[40:43], s68 offen offset:2048 nt lds
    buffer_load_dwordx4 v12, s[40:43], s68 offen offset:3072 nt lds
    s_waitcnt vmcnt(12)
    s_barrier
    s_add_u32 m0, s72, 131072
    s_add_u32 s68, s72, 65536
    buffer_load_dwordx4 v5, s[36:39], s68 offen offset:0 nt lds
    buffer_load_dwordx4 v6, s[36:39], s68 offen offset:1024 nt lds
    buffer_load_dwordx4 v7, s[36:39], s68 offen offset:2048 nt lds
    buffer_load_dwordx4 v8, s[36:39], s68 offen offset:3072 nt lds
    s_add_u32 m0, s72, 147456
    s_add_u32 s68, s72, 65536
    buffer_load_dwordx4 v9, s[40:43], s68 offen offset:0 nt lds
    buffer_load_dwordx4 v12, s[40:43], s68 offen offset:1024 nt lds
    buffer_load_dwordx4 v9, s[40:43], s68 offen offset:2048 nt lds
    buffer_load_dwordx4 v12, s[40:43], s68 offen offset:3072 nt lds
    s_waitcnt vmcnt(12)
    s_barrier
    s_add_u32 m0, s72, 0
    s_add_u32 s68, s72, 81920
    buffer_load_dwordx4 v5, s[36:39], s68 offen offset:0 nt lds
    buffer_load_dwordx4 v6, s[36:39], s68 offen offset:1024 nt lds
    buffer_load_dwordx4 v7, s[36:39], s68 offen offset:2048 nt lds
    buffer_load_dwordx4 v8, s[36:39], s68 offen offset:3072 nt lds
    s_add_u32 m0, s72, 16384
    s_add_u32 s68, s72, 81920
    buffer_load_dwordx4 v9, s[40:43], s68 offen offset:0 nt lds
    buffer_load_dwordx4 v12, s[40:43], s68 offen offset:1024 nt lds
    buffer_load_dwordx4 v9, s[40:43], s68 offen offset:2048 nt lds
    buffer_load_dwordx4 v12, s[40:43], s68 offen offset:3072 nt lds
    s_waitcnt vmcnt(12)
    s_barrier
    s_add_u32 m0, s72, 32768
    s_add_u32 s68, s72, 98304
    buffer_load_dwordx4 v5, s[36:39], s68 offen offset:0 nt lds
    buffer_load_dwordx4 v6, s[36:39], s68 offen offset:1024 nt lds
    buffer_load_dwordx4 v7, s[36:39], s68 offen offset:2048 nt lds
    buffer_load_dwordx4 v8, s[36:39], s68 offen offset:3072 nt lds
    s_add_u32 m0, s72, 49152
    s_add_u32 s68, s72, 98304
    buffer_load_dwordx4 v9, s[40:43], s68 offen offset:0 nt lds
    buffer_load_dwordx4 v12, s[40:43], s68 offen offset:1024 nt lds
    buffer_load_dwordx4 v9, s[40:43], s68 offen offset:2048 nt lds
    buffer_load_dwordx4 v12, s[40:43], s68 offen offset:3072 nt lds
    s_waitcnt vmcnt(12)
    s_barrier
    s_add_u32 m0, s72, 131072
    s_xor_b32 s68, s87, 0
    buffer_load_dwordx4 v112, s[52:55], s68 offen offset:0 lds
    buffer_load_dwordx4 v113, s[52:55], s68 offen offset:1024 lds
    s_add_u32 m0, s72, 133120
    s_xor_b32 s68, s87, 8192
    buffer_load_dwordx4 v112, s[52:55], s68 offen offset:0 lds
    buffer_load_dwordx4 v113, s[52:55], s68 offen offset:1024 lds
    s_waitcnt vmcnt(8)
    s_barrier
    s_add_u32 m0, s72, 147456
    s_xor_b32 s68, s87, 32768
    buffer_load_dwordx4 v112, s[52:55], s68 offen offset:0 lds
    buffer_load_dwordx4 v113, s[52:55], s68 offen offset:1024 lds
    s_add_u32 m0, s72, 149504
    s_xor_b32 s68, s87, 40960
    buffer_load_dwordx4 v112, s[52:55], s68 offen offset:0 lds
    buffer_load_dwordx4 v113, s[52:55], s68 offen offset:1024 lds
    s_add_u32 m0, s72, 65536
    s_add_u32 s68, s72, 114688
    buffer_load_dwordx4 v5, s[36:39], s68 offen offset:0 nt lds
    buffer_load_dwordx4 v6, s[36:39], s68 offen offset:1024 nt lds
    buffer_load_dwordx4 v7, s[36:39], s68 offen offset:2048 nt lds
    buffer_load_dwordx4 v8, s[36:39], s68 offen offset:3072 nt lds
    s_add_u32 m0, s72, 81920
    s_add_u32 s68, s72, 114688
    buffer_load_dwordx4 v9, s[40:43], s68 offen offset:0 nt lds
    buffer_load_dwordx4 v12, s[40:43], s68 offen offset:1024 nt lds
    buffer_load_dwordx4 v9, s[40:43], s68 offen offset:2048 nt lds
    buffer_load_dwordx4 v12, s[40:43], s68 offen offset:3072 nt lds
    s_waitcnt vmcnt(4)
    ds_read_b64_tr_b16 v[128:129], v122 offset:0
    ds_read_b64_tr_b16 v[130:131], v122 offset:1024
    ds_read_b64_tr_b16 v[132:133], v123 offset:0
    ds_read_b64_tr_b16 v[134:135], v123 offset:1024
    ds_read_b64_tr_b16 v[136:137], v122 offset:2048
    ds_read_b64_tr_b16 v[138:139], v122 offset:3072
    ds_read_b64_tr_b16 v[140:141], v123 offset:2048
    ds_read_b64_tr_b16 v[142:143], v123 offset:3072
    s_waitcnt lgkmcnt(0)
    s_barrier
    s_add_u32 m0, s72, 131072
    s_xor_b32 s68, s87, 65536
    buffer_load_dwordx4 v112, s[52:55], s68 offen offset:0 lds
    buffer_load_dwordx4 v113, s[52:55], s68 offen offset:1024 lds
    s_add_u32 m0, s72, 133120
    s_xor_b32 s68, s87, 73728
    buffer_load_dwordx4 v112, s[52:55], s68 offen offset:0 lds
    buffer_load_dwordx4 v113, s[52:55], s68 offen offset:1024 lds
    s_add_u32 m0, s72, 98304
    s_add_u32 s68, s72, 131072
    buffer_load_dwordx4 v5, s[36:39], s68 offen offset:0 nt lds
    buffer_load_dwordx4 v6, s[36:39], s68 offen offset:1024 nt lds
    buffer_load_dwordx4 v7, s[36:39], s68 offen offset:2048 nt lds
    buffer_load_dwordx4 v8, s[36:39], s68 offen offset:3072 nt lds
    s_add_u32 m0, s72, 114688
    s_add_u32 s68, s72, 131072
    buffer_load_dwordx4 v9, s[40:43], s68 offen offset:0 nt lds
    buffer_load_dwordx4 v12, s[40:43], s68 offen offset:1024 nt lds
    buffer_load_dwordx4 v9, s[40:43], s68 offen offset:2048 nt lds
    buffer_load_dwordx4 v12, s[40:43], s68 offen offset:3072 nt lds
    s_waitcnt vmcnt(4)
    ds_read_b64_tr_b16 v[144:145], v122 offset:16384
    ds_read_b64_tr_b16 v[146:147], v122 offset:17408
    ds_read_b64_tr_b16 v[148:149], v123 offset:16384
    ds_read_b64_tr_b16 v[150:151], v123 offset:17408
    ds_read_b64_tr_b16 v[152:153], v122 offset:18432
    ds_read_b64_tr_b16 v[154:155], v122 offset:19456
    ds_read_b64_tr_b16 v[156:157], v123 offset:18432
    ds_read_b64_tr_b16 v[158:159], v123 offset:19456
    s_waitcnt lgkmcnt(0)
    s_barrier
    s_add_u32 m0, s72, 147456
    s_xor_b32 s68, s87, 98304
    buffer_load_dwordx4 v112, s[52:55], s68 offen offset:0 lds
    buffer_load_dwordx4 v113, s[52:55], s68 offen offset:1024 lds
    s_add_u32 m0, s72, 149504
    s_xor_b32 s68, s87, 106496
    buffer_load_dwordx4 v112, s[52:55], s68 offen offset:0 lds
    buffer_load_dwordx4 v113, s[52:55], s68 offen offset:1024 lds
    s_add_u32 m0, s72, 0
    s_add_u32 s68, s72, 147456
    buffer_load_dwordx4 v5, s[36:39], s68 offen offset:0 nt lds
    buffer_load_dwordx4 v6, s[36:39], s68 offen offset:1024 nt lds
    buffer_load_dwordx4 v7, s[36:39], s68 offen offset:2048 nt lds
    buffer_load_dwordx4 v8, s[36:39], s68 offen offset:3072 nt lds
    s_add_u32 m0, s72, 16384
    s_add_u32 s68, s72, 147456
    buffer_load_dwordx4 v9, s[40:43], s68 offen offset:0 nt lds
    buffer_load_dwordx4 v12, s[40:43], s68 offen offset:1024 nt lds
    buffer_load_dwordx4 v9, s[40:43], s68 offen offset:2048 nt lds
    buffer_load_dwordx4 v12, s[40:43], s68 offen offset:3072 nt lds
    s_waitcnt vmcnt(4)
    ds_read_b64_tr_b16 v[160:161], v122 offset:0
    ds_read_b64_tr_b16 v[162:163], v122 offset:1024
    ds_read_b64_tr_b16 v[164:165], v123 offset:0
    ds_read_b64_tr_b16 v[166:167], v123 offset:1024
    ds_read_b64_tr_b16 v[168:169], v122 offset:2048
    ds_read_b64_tr_b16 v[170:171], v122 offset:3072
    ds_read_b64_tr_b16 v[172:173], v123 offset:2048
    ds_read_b64_tr_b16 v[174:175], v123 offset:3072
    s_waitcnt lgkmcnt(0)
    s_barrier
    s_add_u32 m0, s72, 131072
    s_xor_b32 s68, s87, 131072
    buffer_load_dwordx4 v112, s[52:55], s68 offen offset:0 lds
    buffer_load_dwordx4 v113, s[52:55], s68 offen offset:1024 lds
    s_add_u32 m0, s72, 133120
    s_xor_b32 s68, s87, 139264
    buffer_load_dwordx4 v112, s[52:55], s68 offen offset:0 lds
    buffer_load_dwordx4 v113, s[52:55], s68 offen offset:1024 lds
    s_add_u32 m0, s72, 32768
    s_add_u32 s68, s72, 163840
    buffer_load_dwordx4 v5, s[36:39], s68 offen offset:0 nt lds
    buffer_load_dwordx4 v6, s[36:39], s68 offen offset:1024 nt lds
    buffer_load_dwordx4 v7, s[36:39], s68 offen offset:2048 nt lds
    buffer_load_dwordx4 v8, s[36:39], s68 offen offset:3072 nt lds
    s_add_u32 m0, s72, 49152
    s_add_u32 s68, s72, 163840
    buffer_load_dwordx4 v9, s[40:43], s68 offen offset:0 nt lds
    buffer_load_dwordx4 v12, s[40:43], s68 offen offset:1024 nt lds
    buffer_load_dwordx4 v9, s[40:43], s68 offen offset:2048 nt lds
    buffer_load_dwordx4 v12, s[40:43], s68 offen offset:3072 nt lds
    s_waitcnt vmcnt(4)
    ds_read_b64_tr_b16 v[176:177], v122 offset:16384
    ds_read_b64_tr_b16 v[178:179], v122 offset:17408
    ds_read_b64_tr_b16 v[180:181], v123 offset:16384
    ds_read_b64_tr_b16 v[182:183], v123 offset:17408
    ds_read_b64_tr_b16 v[184:185], v122 offset:18432
    ds_read_b64_tr_b16 v[186:187], v122 offset:19456
    ds_read_b64_tr_b16 v[188:189], v123 offset:18432
    ds_read_b64_tr_b16 v[190:191], v123 offset:19456
    s_waitcnt lgkmcnt(0)
    s_barrier
    s_add_u32 m0, s72, 147456
    s_xor_b32 s68, s87, 163840
    buffer_load_dwordx4 v112, s[52:55], s68 offen offset:0 lds
    buffer_load_dwordx4 v113, s[52:55], s68 offen offset:1024 lds
    s_add_u32 m0, s72, 149504
    s_xor_b32 s68, s87, 172032
    buffer_load_dwordx4 v112, s[52:55], s68 offen offset:0 lds
    buffer_load_dwordx4 v113, s[52:55], s68 offen offset:1024 lds
    s_add_u32 m0, s72, 65536
    s_add_u32 s68, s72, 180224
    buffer_load_dwordx4 v5, s[36:39], s68 offen offset:0 nt lds
    buffer_load_dwordx4 v6, s[36:39], s68 offen offset:1024 nt lds
    buffer_load_dwordx4 v7, s[36:39], s68 offen offset:2048 nt lds
    buffer_load_dwordx4 v8, s[36:39], s68 offen offset:3072 nt lds
    s_add_u32 m0, s72, 81920
    s_add_u32 s68, s72, 180224
    buffer_load_dwordx4 v9, s[40:43], s68 offen offset:0 nt lds
    buffer_load_dwordx4 v12, s[40:43], s68 offen offset:1024 nt lds
    buffer_load_dwordx4 v9, s[40:43], s68 offen offset:2048 nt lds
    buffer_load_dwordx4 v12, s[40:43], s68 offen offset:3072 nt lds
    s_waitcnt vmcnt(4)
    ds_read_b64_tr_b16 v[192:193], v122 offset:0
    ds_read_b64_tr_b16 v[194:195], v122 offset:1024
    ds_read_b64_tr_b16 v[196:197], v123 offset:0
    ds_read_b64_tr_b16 v[198:199], v123 offset:1024
    ds_read_b64_tr_b16 v[200:201], v122 offset:2048
    ds_read_b64_tr_b16 v[202:203], v122 offset:3072
    ds_read_b64_tr_b16 v[204:205], v123 offset:2048
    ds_read_b64_tr_b16 v[206:207], v123 offset:3072
    s_waitcnt lgkmcnt(0)
    s_barrier
    s_add_u32 m0, s72, 131072
    s_xor_b32 s68, s87, 196608
    buffer_load_dwordx4 v112, s[52:55], s68 offen offset:0 lds
    buffer_load_dwordx4 v113, s[52:55], s68 offen offset:1024 lds
    s_add_u32 m0, s72, 133120
    s_xor_b32 s68, s87, 204800
    buffer_load_dwordx4 v112, s[52:55], s68 offen offset:0 lds
    buffer_load_dwordx4 v113, s[52:55], s68 offen offset:1024 lds
    s_add_u32 m0, s72, 98304
    s_add_u32 s68, s72, 196608
    buffer_load_dwordx4 v5, s[36:39], s68 offen offset:0 nt lds
    buffer_load_dwordx4 v6, s[36:39], s68 offen offset:1024 nt lds
    buffer_load_dwordx4 v7, s[36:39], s68 offen offset:2048 nt lds
    buffer_load_dwordx4 v8, s[36:39], s68 offen offset:3072 nt lds
    s_add_u32 m0, s72, 114688
    s_add_u32 s68, s72, 196608
    buffer_load_dwordx4 v9, s[40:43], s68 offen offset:0 nt lds
    buffer_load_dwordx4 v12, s[40:43], s68 offen offset:1024 nt lds
    buffer_load_dwordx4 v9, s[40:43], s68 offen offset:2048 nt lds
    buffer_load_dwordx4 v12, s[40:43], s68 offen offset:3072 nt lds
    s_waitcnt vmcnt(4)
    ds_read_b64_tr_b16 v[208:209], v122 offset:16384
    ds_read_b64_tr_b16 v[210:211], v122 offset:17408
    ds_read_b64_tr_b16 v[212:213], v123 offset:16384
    ds_read_b64_tr_b16 v[214:215], v123 offset:17408
    ds_read_b64_tr_b16 v[216:217], v122 offset:18432
    ds_read_b64_tr_b16 v[218:219], v122 offset:19456
    ds_read_b64_tr_b16 v[220:221], v123 offset:18432
    ds_read_b64_tr_b16 v[222:223], v123 offset:19456
    s_waitcnt lgkmcnt(0)
    s_barrier
    s_add_u32 m0, s72, 147456
    s_xor_b32 s68, s87, 229376
    buffer_load_dwordx4 v112, s[52:55], s68 offen offset:0 lds
    buffer_load_dwordx4 v113, s[52:55], s68 offen offset:1024 lds
    s_add_u32 m0, s72, 149504
    s_xor_b32 s68, s87, 237568
    buffer_load_dwordx4 v112, s[52:55], s68 offen offset:0 lds
    buffer_load_dwordx4 v113, s[52:55], s68 offen offset:1024 lds
    s_add_u32 m0, s72, 0
    s_add_u32 s68, s72, 212992
    buffer_load_dwordx4 v5, s[36:39], s68 offen offset:0 nt lds
    buffer_load_dwordx4 v6, s[36:39], s68 offen offset:1024 nt lds
    buffer_load_dwordx4 v7, s[36:39], s68 offen offset:2048 nt lds
    buffer_load_dwordx4 v8, s[36:39], s68 offen offset:3072 nt lds
    s_add_u32 m0, s72, 16384
    s_add_u32 s68, s72, 212992
    buffer_load_dwordx4 v9, s[40:43], s68 offen offset:0 nt lds
    buffer_load_dwordx4 v12, s[40:43], s68 offen offset:1024 nt lds
    buffer_load_dwordx4 v9, s[40:43], s68 offen offset:2048 nt lds
    buffer_load_dwordx4 v12, s[40:43], s68 offen offset:3072 nt lds
    s_waitcnt vmcnt(4)
    ds_read_b64_tr_b16 v[224:225], v122 offset:0
    ds_read_b64_tr_b16 v[226:227], v122 offset:1024
    ds_read_b64_tr_b16 v[228:229], v123 offset:0
    ds_read_b64_tr_b16 v[230:231], v123 offset:1024
    ds_read_b64_tr_b16 v[232:233], v122 offset:2048
    ds_read_b64_tr_b16 v[234:235], v122 offset:3072
    ds_read_b64_tr_b16 v[236:237], v123 offset:2048
    ds_read_b64_tr_b16 v[238:239], v123 offset:3072
    s_waitcnt lgkmcnt(0)
    s_barrier
    s_add_u32 m0, s72, 32768
    s_add_u32 s68, s72, 229376
    buffer_load_dwordx4 v5, s[36:39], s68 offen offset:0 nt lds
    buffer_load_dwordx4 v6, s[36:39], s68 offen offset:1024 nt lds
    buffer_load_dwordx4 v7, s[36:39], s68 offen offset:2048 nt lds
    buffer_load_dwordx4 v8, s[36:39], s68 offen offset:3072 nt lds
    s_add_u32 m0, s72, 49152
    s_add_u32 s68, s72, 229376
    buffer_load_dwordx4 v9, s[40:43], s68 offen offset:0 nt lds
    buffer_load_dwordx4 v12, s[40:43], s68 offen offset:1024 nt lds
    buffer_load_dwordx4 v9, s[40:43], s68 offen offset:2048 nt lds
    buffer_load_dwordx4 v12, s[40:43], s68 offen offset:3072 nt lds
    s_xor_b32 s68, s87, 0
    s_add_u32 m0, s84, 122880
    s_sub_u32 s68, s68, 512
    buffer_load_dwordx4 v112, s[52:55], s68 offen offset:0 lds
    buffer_load_dwordx4 v113, s[52:55], s68 offen offset:1024 lds
    s_xor_b32 s68, s87, 262144
    s_add_u32 m0, s84, 131072
    s_sub_u32 s68, s68, 0
    buffer_load_dwordx4 v112, s[52:55], s68 offen offset:0 lds
    buffer_load_dwordx4 v113, s[52:55], s68 offen offset:1024 lds
    s_waitcnt vmcnt(8)
    ds_read_b64_tr_b16 v[240:241], v122 offset:16384
    ds_read_b64_tr_b16 v[242:243], v122 offset:17408
    ds_read_b64_tr_b16 v[244:245], v123 offset:16384
    ds_read_b64_tr_b16 v[246:247], v123 offset:17408
    ds_read_b64_tr_b16 v[248:249], v122 offset:18432
    ds_read_b64_tr_b16 v[250:251], v122 offset:19456
    ds_read_b64_tr_b16 v[252:253], v123 offset:18432
    ds_read_b64_tr_b16 v[254:255], v123 offset:19456
    s_waitcnt lgkmcnt(0)
    s_barrier
    s_add_u32 m0, s72, 65536
    s_add_u32 s68, s72, 245760
    buffer_load_dwordx4 v5, s[36:39], s68 offen offset:0 nt lds
    buffer_load_dwordx4 v6, s[36:39], s68 offen offset:1024 nt lds
    buffer_load_dwordx4 v7, s[36:39], s68 offen offset:2048 nt lds
    buffer_load_dwordx4 v8, s[36:39], s68 offen offset:3072 nt lds
    s_add_u32 m0, s72, 81920
    s_add_u32 s68, s72, 245760
    buffer_load_dwordx4 v9, s[40:43], s68 offen offset:0 nt lds
    buffer_load_dwordx4 v12, s[40:43], s68 offen offset:1024 nt lds
    buffer_load_dwordx4 v9, s[40:43], s68 offen offset:2048 nt lds
    buffer_load_dwordx4 v12, s[40:43], s68 offen offset:3072 nt lds
    s_xor_b32 s68, s87, 8192
    s_add_u32 m0, s84, 139264
    s_sub_u32 s68, s68, 512
    buffer_load_dwordx4 v112, s[52:55], s68 offen offset:0 lds
    buffer_load_dwordx4 v113, s[52:55], s68 offen offset:1024 lds
    s_xor_b32 s68, s87, 270336
    s_add_u32 m0, s84, 147456
    s_sub_u32 s68, s68, 0
    buffer_load_dwordx4 v112, s[52:55], s68 offen offset:0 lds
    buffer_load_dwordx4 v113, s[52:55], s68 offen offset:1024 lds
    s_waitcnt vmcnt(8)
    s_barrier
    s_xor_b32 s68, s87, 32768
    s_add_u32 m0, s84, 90112
    s_sub_u32 s68, s68, 512
    buffer_load_dwordx4 v112, s[52:55], s68 offen offset:0 lds
    buffer_load_dwordx4 v113, s[52:55], s68 offen offset:1024 lds
    s_xor_b32 s68, s87, 294912
    s_add_u32 m0, s84, 98304
    s_sub_u32 s68, s68, 0
    buffer_load_dwordx4 v112, s[52:55], s68 offen offset:0 lds
    buffer_load_dwordx4 v113, s[52:55], s68 offen offset:1024 lds
    s_xor_b32 s68, s87, 40960
    s_add_u32 m0, s84, 106496
    s_sub_u32 s68, s68, 512
    buffer_load_dwordx4 v112, s[52:55], s68 offen offset:0 lds
    buffer_load_dwordx4 v113, s[52:55], s68 offen offset:1024 lds
    s_xor_b32 s68, s87, 303104
    s_add_u32 m0, s84, 114688
    s_sub_u32 s68, s68, 0
    buffer_load_dwordx4 v112, s[52:55], s68 offen offset:0 lds
    buffer_load_dwordx4 v113, s[52:55], s68 offen offset:1024 lds
    s_waitcnt vmcnt(12)
    s_branch L_hmerge
L_hkv:
    v_lshrrev_b32 v112, 3, v0
    v_and_b32 v113, 7, v0
    v_bfe_u32 v114, v0, 4, 1
    v_lshlrev_b32 v114, 2, v114
    v_xor_b32 v113, v113, v114
    v_lshlrev_b32 v113, 4, v113
    v_lshl_add_u32 v112, v112, 10, v113
    v_add_u32 v113, 15360, v112
    v_and_b32 v114, 1, v0
    v_bfe_u32 v115, v0, 1, 1
    v_lshlrev_b32 v114, 4, v114
    v_lshl_add_u32 v114, v115, 3, v114
    v_and_b32 v115, 1, v1
    v_lshl_add_u32 v114, v115, 5, v114
    v_lshl_add_u32 v114, v3, 9, v114
    v_bfe_u32 v115, v0, 2, 2
    v_lshl_add_u32 v114, v115, 7, v114
    v_bfe_u32 v115, v0, 3, 1
    v_lshl_add_u32 v121, v115, 6, v114
    v_add_u32 v114, s84, v121
    v_xor_b32 v115, 64, v114
    v_add_u32 v116, 65536, v114
    v_add_u32 v117, 65536, v115
    v_add_u32 v118, 131072, v114
    v_add_u32 v119, 131072, v115
    v_add_u32 v120, 49152, v4
    v_add_u32 v13, s72, v4
    v_add_u32 v11, s72, v4
    v_add_u32 v10, 131072, v11
    v_add_u32 v11, 65536, v11
    v_add_u32 v122, s72, v121
    v_add_u32 v122, 131072, v122
    v_xor_b32 v123, 64, v122
    s_waitcnt vmcnt(8)
    s_barrier
    s_add_u32 m0, s72, 32768
    s_add_u32 s68, s72, 16384
    buffer_load_dwordx4 v5, s[36:39], s68 offen offset:0 nt lds
    buffer_load_dwordx4 v6, s[36:39], s68 offen offset:1024 nt lds
    buffer_load_dwordx4 v7, s[36:39], s68 offen offset:2048 nt lds
    buffer_load_dwordx4 v8, s[36:39], s68 offen offset:3072 nt lds
    s_add_u32 m0, s72, 49152
    s_add_u32 s68, s72, 16384
    buffer_load_dwordx4 v9, s[40:43], s68 offen offset:0 nt lds
    buffer_load_dwordx4 v12, s[40:43], s68 offen offset:1024 nt lds
    buffer_load_dwordx4 v9, s[40:43], s68 offen offset:2048 nt lds
    buffer_load_dwordx4 v12, s[40:43], s68 offen offset:3072 nt lds
    s_barrier
    s_add_u32 m0, s72, 65536
    s_add_u32 s68, s72, 32768
    buffer_load_dwordx4 v5, s[36:39], s68 offen offset:0 nt lds
    buffer_load_dwordx4 v6, s[36:39], s68 offen offset:1024 nt lds
    buffer_load_dwordx4 v7, s[36:39], s68 offen offset:2048 nt lds
    buffer_load_dwordx4 v8, s[36:39], s68 offen offset:3072 nt lds
    s_add_u32 m0, s72, 81920
    s_add_u32 s68, s72, 32768
    buffer_load_dwordx4 v9, s[40:43], s68 offen offset:0 nt lds
    buffer_load_dwordx4 v12, s[40:43], s68 offen offset:1024 nt lds
    buffer_load_dwordx4 v9, s[40:43], s68 offen offset:2048 nt lds
    buffer_load_dwordx4 v12, s[40:43], s68 offen offset:3072 nt lds
    s_add_u32 s68, s72, 49152
    buffer_load_dwordx4 v[128:131], v5, s[36:39], s68 offen offset:0 nt
    buffer_load_dwordx4 v[132:135], v6, s[36:39], s68 offen offset:1024 nt
    buffer_load_dwordx4 v[136:139], v7, s[36:39], s68 offen offset:2048 nt
    buffer_load_dwordx4 v[140:143], v8, s[36:39], s68 offen offset:3072 nt
    s_add_u32 s68, s72, 49152
    buffer_load_dwordx4 v[144:147], v9, s[40:43], s68 offen offset:0 nt
    buffer_load_dwordx4 v[148:151], v12, s[40:43], s68 offen offset:1024 nt
    buffer_load_dwordx4 v[152:155], v9, s[40:43], s68 offen offset:2048 nt
    buffer_load_dwordx4 v[156:159], v12, s[40:43], s68 offen offset:3072 nt
    s_add_u32 s68, s72, 65536
    buffer_load_dwordx4 v[160:163], v5, s[36:39], s68 offen offset:0 nt
    buffer_load_dwordx4 v[164:167], v6, s[36:39], s68 offen offset:1024 nt
    buffer_load_dwordx4 v[168:171], v7, s[36:39], s68 offen offset:2048 nt
    buffer_load_dwordx4 v[172:175], v8, s[36:39], s68 offen offset:3072 nt
    s_add_u32 s68, s72, 65536
    buffer_load_dwordx4 v[176:179], v9, s[40:43], s68 offen offset:0 nt
    buffer_load_dwordx4 v[180:183], v12, s[40:43], s68 offen offset:1024 nt
    buffer_load_dwordx4 v[184:187], v9, s[40:43], s68 offen offset:2048 nt
    buffer_load_dwordx4 v[188:191], v12, s[40:43], s68 offen offset:3072 nt
    s_add_u32 s68, s72, 81920
    buffer_load_dwordx4 v[192:195], v5, s[36:39], s68 offen offset:0 nt
    buffer_load_dwordx4 v[196:199], v6, s[36:39], s68 offen offset:1024 nt
    buffer_load_dwordx4 v[200:203], v7, s[36:39], s68 offen offset:2048 nt
    buffer_load_dwordx4 v[204:207], v8, s[36:39], s68 offen offset:3072 nt
    s_barrier
    s_barrier
    s_waitcnt vmcnt(0)
    s_barrier
    ds_write_b128 v11, v[128:131] offset:32768
    ds_write_b128 v11, v[132:135] offset:33792
    ds_write_b128 v11, v[136:139] offset:34816
    ds_write_b128 v11, v[140:143] offset:35840
    ds_write_b128 v11, v[144:147] offset:49152
    ds_write_b128 v11, v[148:151] offset:50176
    ds_write_b128 v11, v[152:155] offset:51200
    ds_write_b128 v11, v[156:159] offset:52224
    s_waitcnt vmcnt(40)
    s_barrier
    s_setprio 0
    ds_write_b128 v10, v[160:163] offset:0
    ds_write_b128 v10, v[164:167] offset:1024
    ds_write_b128 v10, v[168:171] offset:2048
    ds_write_b128 v10, v[172:175] offset:3072
    ds_write_b128 v10, v[176:179] offset:16384
    ds_write_b128 v10, v[180:183] offset:17408
    ds_write_b128 v10, v[184:187] offset:18432
    ds_write_b128 v10, v[188:191] offset:19456
    s_setprio 1
    s_waitcnt vmcnt(32)
    s_waitcnt lgkmcnt(0)
    s_barrier
    s_setprio 0
    ds_write_b128 v13, v[192:195] offset:0
    ds_write_b128 v13, v[196:199] offset:1024
    ds_write_b128 v13, v[200:203] offset:2048
    ds_write_b128 v13, v[204:207] offset:3072
    s_setprio 1
    s_waitcnt vmcnt(24)
    s_waitcnt lgkmcnt(0)
    s_barrier
    s_add_u32 m0, s72, 16384
    s_add_u32 s68, s72, 81920
    buffer_load_dwordx4 v9, s[40:43], s68 offen offset:0 nt lds
    buffer_load_dwordx4 v12, s[40:43], s68 offen offset:1024 nt lds
    buffer_load_dwordx4 v9, s[40:43], s68 offen offset:2048 nt lds
    buffer_load_dwordx4 v12, s[40:43], s68 offen offset:3072 nt lds
    s_waitcnt vmcnt(20)
    s_waitcnt lgkmcnt(0)
    s_barrier
    s_add_u32 m0, s72, 32768
    s_add_u32 s68, s72, 98304
    buffer_load_dwordx4 v5, s[36:39], s68 offen offset:0 nt lds
    buffer_load_dwordx4 v6, s[36:39], s68 offen offset:1024 nt lds
    buffer_load_dwordx4 v7, s[36:39], s68 offen offset:2048 nt lds
    buffer_load_dwordx4 v8, s[36:39], s68 offen offset:3072 nt lds
    s_add_u32 m0, s72, 49152
    s_add_u32 s68, s72, 98304
    buffer_load_dwordx4 v9, s[40:43], s68 offen offset:0 nt lds
    buffer_load_dwordx4 v12, s[40:43], s68 offen offset:1024 nt lds
    buffer_load_dwordx4 v9, s[40:43], s68 offen offset:2048 nt lds
    buffer_load_dwordx4 v12, s[40:43], s68 offen offset:3072 nt lds
    s_waitcnt vmcnt(20)
    s_waitcnt lgkmcnt(0)
    s_barrier
    s_add_u32 m0, s72, 65536
    s_add_u32 s68, s72, 114688
    buffer_load_dwordx4 v5, s[36:39], s68 offen offset:0 nt lds
    buffer_load_dwordx4 v6, s[36:39], s68 offen offset:1024 nt lds
    buffer_load_dwordx4 v7, s[36:39], s68 offen offset:2048 nt lds
    buffer_load_dwordx4 v8, s[36:39], s68 offen offset:3072 nt lds
    s_add_u32 m0, s72, 81920
    s_add_u32 s68, s72, 114688
    buffer_load_dwordx4 v9, s[40:43], s68 offen offset:0 nt lds
    buffer_load_dwordx4 v12, s[40:43], s68 offen offset:1024 nt lds
    buffer_load_dwordx4 v9, s[40:43], s68 offen offset:2048 nt lds
    buffer_load_dwordx4 v12, s[40:43], s68 offen offset:3072 nt lds
    s_waitcnt vmcnt(20)
    s_waitcnt lgkmcnt(0)
    s_barrier
    s_add_u32 m0, s72, 131072
    s_xor_b32 s68, s87, 0
    buffer_load_dwordx4 v112, s[52:55], s68 offen offset:0 lds
    buffer_load_dwordx4 v113, s[52:55], s68 offen offset:1024 lds
    s_add_u32 m0, s72, 133120
    s_xor_b32 s68, s87, 8192
    buffer_load_dwordx4 v112, s[52:55], s68 offen offset:0 lds
    buffer_load_dwordx4 v113, s[52:55], s68 offen offset:1024 lds
    s_add_u32 m0, s72, 98304
    s_add_u32 s68, s72, 131072
    buffer_load_dwordx4 v5, s[36:39], s68 offen offset:0 nt lds
    buffer_load_dwordx4 v6, s[36:39], s68 offen offset:1024 nt lds
    buffer_load_dwordx4 v7, s[36:39], s68 offen offset:2048 nt lds
    buffer_load_dwordx4 v8, s[36:39], s68 offen offset:3072 nt lds
    s_add_u32 m0, s72, 114688
    s_add_u32 s68, s72, 131072
    buffer_load_dwordx4 v9, s[40:43], s68 offen offset:0 nt lds
    buffer_load_dwordx4 v12, s[40:43], s68 offen offset:1024 nt lds
    buffer_load_dwordx4 v9, s[40:43], s68 offen offset:2048 nt lds
    buffer_load_dwordx4 v12, s[40:43], s68 offen offset:3072 nt lds
    s_waitcnt vmcnt(24)
    s_barrier
    s_add_u32 m0, s72, 147456
    s_xor_b32 s68, s87, 32768
    buffer_load_dwordx4 v112, s[52:55], s68 offen offset:0 lds
    buffer_load_dwordx4 v113, s[52:55], s68 offen offset:1024 lds
    s_add_u32 m0, s72, 149504
    s_xor_b32 s68, s87, 40960
    buffer_load_dwordx4 v112, s[52:55], s68 offen offset:0 lds
    buffer_load_dwordx4 v113, s[52:55], s68 offen offset:1024 lds
    s_add_u32 m0, s72, 0
    s_add_u32 s68, s72, 147456
    buffer_load_dwordx4 v5, s[36:39], s68 offen offset:0 nt lds
    buffer_load_dwordx4 v6, s[36:39], s68 offen offset:1024 nt lds
    buffer_load_dwordx4 v7, s[36:39], s68 offen offset:2048 nt lds
    buffer_load_dwordx4 v8, s[36:39], s68 offen offset:3072 nt lds
    s_waitcnt vmcnt(16)
    ds_read_b64_tr_b16 v[128:129], v122 offset:0
    ds_read_b64_tr_b16 v[130:131], v122 offset:1024
    ds_read_b64_tr_b16 v[132:133], v123 offset:0
    ds_read_b64_tr_b16 v[134:135], v123 offset:1024
    ds_read_b64_tr_b16 v[136:137], v122 offset:2048
    ds_read_b64_tr_b16 v[138:139], v122 offset:3072
    ds_read_b64_tr_b16 v[140:141], v123 offset:2048
    ds_read_b64_tr_b16 v[142:143], v123 offset:3072
    s_waitcnt lgkmcnt(0)
    s_barrier
    s_add_u32 m0, s72, 131072
    s_xor_b32 s68, s87, 65536
    buffer_load_dwordx4 v112, s[52:55], s68 offen offset:0 lds
    buffer_load_dwordx4 v113, s[52:55], s68 offen offset:1024 lds
    s_add_u32 m0, s72, 133120
    s_xor_b32 s68, s87, 73728
    buffer_load_dwordx4 v112, s[52:55], s68 offen offset:0 lds
    buffer_load_dwordx4 v113, s[52:55], s68 offen offset:1024 lds
    s_add_u32 m0, s72, 16384
    s_add_u32 s68, s72, 147456
    buffer_load_dwordx4 v9, s[40:43], s68 offen offset:0 nt lds
    buffer_load_dwordx4 v12, s[40:43], s68 offen offset:1024 nt lds
    buffer_load_dwordx4 v9, s[40:43], s68 offen offset:2048 nt lds
    buffer_load_dwordx4 v12, s[40:43], s68 offen offset:3072 nt lds
    s_add_u32 m0, s72, 32768
    s_add_u32 s68, s72, 163840
    buffer_load_dwordx4 v5, s[36:39], s68 offen offset:0 nt lds
    buffer_load_dwordx4 v6, s[36:39], s68 offen offset:1024 nt lds
    buffer_load_dwordx4 v7, s[36:39], s68 offen offset:2048 nt lds
    buffer_load_dwordx4 v8, s[36:39], s68 offen offset:3072 nt lds
    s_waitcnt vmcnt(16)
    ds_read_b64_tr_b16 v[144:145], v122 offset:16384
    ds_read_b64_tr_b16 v[146:147], v122 offset:17408
    ds_read_b64_tr_b16 v[148:149], v123 offset:16384
    ds_read_b64_tr_b16 v[150:151], v123 offset:17408
    ds_read_b64_tr_b16 v[152:153], v122 offset:18432
    ds_read_b64_tr_b16 v[154:155], v122 offset:19456
    ds_read_b64_tr_b16 v[156:157], v123 offset:18432
    ds_read_b64_tr_b16 v[158:159], v123 offset:19456
    s_waitcnt lgkmcnt(0)
    s_barrier
    s_add_u32 m0, s72, 147456
    s_xor_b32 s68, s87, 98304
    buffer_load_dwordx4 v112, s[52:55], s68 offen offset:0 lds
    buffer_load_dwordx4 v113, s[52:55], s68 offen offset:1024 lds
    s_add_u32 m0, s72, 149504
    s_xor_b32 s68, s87, 106496
    buffer_load_dwordx4 v112, s[52:55], s68 offen offset:0 lds
    buffer_load_dwordx4 v113, s[52:55], s68 offen offset:1024 lds
    s_add_u32 m0, s72, 49152
    s_add_u32 s68, s72, 163840
    buffer_load_dwordx4 v9, s[40:43], s68 offen offset:0 nt lds
    buffer_load_dwordx4 v12, s[40:43], s68 offen offset:1024 nt lds
    buffer_load_dwordx4 v9, s[40:43], s68 offen offset:2048 nt lds
    buffer_load_dwordx4 v12, s[40:43], s68 offen offset:3072 nt lds
    s_add_u32 m0, s72, 65536
    s_add_u32 s68, s72, 180224
    buffer_load_dwordx4 v5, s[36:39], s68 offen offset:0 nt lds
    buffer_load_dwordx4 v6, s[36:39], s68 offen offset:1024 nt lds
    buffer_load_dwordx4 v7, s[36:39], s68 offen offset:2048 nt lds
    buffer_load_dwordx4 v8, s[36:39], s68 offen offset:3072 nt lds
    s_waitcnt vmcnt(20)
    ds_read_b64_tr_b16 v[160:161], v122 offset:0
    ds_read_b64_tr_b16 v[162:163], v122 offset:1024
    ds_read_b64_tr_b16 v[164:165], v123 offset:0
    ds_read_b64_tr_b16 v[166:167], v123 offset:1024
    ds_read_b64_tr_b16 v[168:169], v122 offset:2048
    ds_read_b64_tr_b16 v[170:171], v122 offset:3072
    ds_read_b64_tr_b16 v[172:173], v123 offset:2048
    ds_read_b64_tr_b16 v[174:175], v123 offset:3072
    s_waitcnt lgkmcnt(0)
    s_barrier
    s_add_u32 m0, s72, 131072
    s_xor_b32 s68, s87, 131072
    buffer_load_dwordx4 v112, s[52:55], s68 offen offset:0 lds
    buffer_load_dwordx4 v113, s[52:55], s68 offen offset:1024 lds
    s_add_u32 m0, s72, 133120
    s_xor_b32 s68, s87, 139264
    buffer_load_dwordx4 v112, s[52:55], s68 offen offset:0 lds
    buffer_load_dwordx4 v113, s[52:55], s68 offen offset:1024 lds
    s_add_u32 m0, s72, 81920
    s_add_u32 s68, s72, 180224
    buffer_load_dwordx4 v9, s[40:43], s68 offen offset:0 nt lds
    buffer_load_dwordx4 v12, s[40:43], s68 offen offset:1024 nt lds
    buffer_load_dwordx4 v9, s[40:43], s68 offen offset:2048 nt lds
    buffer_load_dwordx4 v12, s[40:43], s68 offen offset:3072 nt lds
    s_add_u32 m0, s72, 98304
    s_add_u32 s68, s72, 196608
    buffer_load_dwordx4 v5, s[36:39], s68 offen offset:0 nt lds
    buffer_load_dwordx4 v6, s[36:39], s68 offen offset:1024 nt lds
    buffer_load_dwordx4 v7, s[36:39], s68 offen offset:2048 nt lds
    buffer_load_dwordx4 v8, s[36:39], s68 offen offset:3072 nt lds
    s_waitcnt vmcnt(20)
    ds_read_b64_tr_b16 v[176:177], v122 offset:16384
    ds_read_b64_tr_b16 v[178:179], v122 offset:17408
    ds_read_b64_tr_b16 v[180:181], v123 offset:16384
    ds_read_b64_tr_b16 v[182:183], v123 offset:17408
    ds_read_b64_tr_b16 v[184:185], v122 offset:18432
    ds_read_b64_tr_b16 v[186:187], v122 offset:19456
    ds_read_b64_tr_b16 v[188:189], v123 offset:18432
    ds_read_b64_tr_b16 v[190:191], v123 offset:19456
    s_waitcnt lgkmcnt(0)
    s_barrier
    s_add_u32 m0, s72, 147456
    s_xor_b32 s68, s87, 163840
    buffer_load_dwordx4 v112, s[52:55], s68 offen offset:0 lds
    buffer_load_dwordx4 v113, s[52:55], s68 offen offset:1024 lds
    s_add_u32 m0, s72, 149504
    s_xor_b32 s68, s87, 172032
    buffer_load_dwordx4 v112, s[52:55], s68 offen offset:0 lds
    buffer_load_dwordx4 v113, s[52:55], s68 offen offset:1024 lds
    s_add_u32 m0, s72, 114688
    s_add_u32 s68, s72, 196608
    buffer_load_dwordx4 v9, s[40:43], s68 offen offset:0 nt lds
    buffer_load_dwordx4 v12, s[40:43], s68 offen offset:1024 nt lds
    buffer_load_dwordx4 v9, s[40:43], s68 offen offset:2048 nt lds
    buffer_load_dwordx4 v12, s[40:43], s68 offen offset:3072 nt lds
    s_add_u32 m0, s72, 0
    s_add_u32 s68, s72, 212992
    buffer_load_dwordx4 v5, s[36:39], s68 offen offset:0 nt lds
    buffer_load_dwordx4 v6, s[36:39], s68 offen offset:1024 nt lds
    buffer_load_dwordx4 v7, s[36:39], s68 offen offset:2048 nt lds
    buffer_load_dwordx4 v8, s[36:39], s68 offen offset:3072 nt lds
    s_waitcnt vmcnt(20)
    ds_read_b64_tr_b16 v[192:193], v122 offset:0
    ds_read_b64_tr_b16 v[194:195], v122 offset:1024
    ds_read_b64_tr_b16 v[196:197], v123 offset:0
    ds_read_b64_tr_b16 v[198:199], v123 offset:1024
    ds_read_b64_tr_b16 v[200:201], v122 offset:2048
    ds_read_b64_tr_b16 v[202:203], v122 offset:3072
    ds_read_b64_tr_b16 v[204:205], v123 offset:2048
    ds_read_b64_tr_b16 v[206:207], v123 offset:3072
    s_waitcnt lgkmcnt(0)
    s_barrier
    s_add_u32 m0, s72, 131072
    s_xor_b32 s68, s87, 196608
    buffer_load_dwordx4 v112, s[52:55], s68 offen offset:0 lds
    buffer_load_dwordx4 v113, s[52:55], s68 offen offset:1024 lds
    s_add_u32 m0, s72, 133120
    s_xor_b32 s68, s87, 204800
    buffer_load_dwordx4 v112, s[52:55], s68 offen offset:0 lds
    buffer_load_dwordx4 v113, s[52:55], s68 offen offset:1024 lds
    s_add_u32 m0, s72, 16384
    s_add_u32 s68, s72, 212992
    buffer_load_dwordx4 v9, s[40:43], s68 offen offset:0 nt lds
    buffer_load_dwordx4 v12, s[40:43], s68 offen offset:1024 nt lds
    buffer_load_dwordx4 v9, s[40:43], s68 offen offset:2048 nt lds
    buffer_load_dwordx4 v12, s[40:43], s68 offen offset:3072 nt lds
    s_add_u32 m0, s72, 32768
    s_add_u32 s68, s72, 229376
    buffer_load_dwordx4 v5, s[36:39], s68 offen offset:0 nt lds
    buffer_load_dwordx4 v6, s[36:39], s68 offen offset:1024 nt lds
    buffer_load_dwordx4 v7, s[36:39], s68 offen offset:2048 nt lds
    buffer_load_dwordx4 v8, s[36:39], s68 offen offset:3072 nt lds
    s_waitcnt vmcnt(20)
    ds_read_b64_tr_b16 v[208:209], v122 offset:16384
    ds_read_b64_tr_b16 v[210:211], v122 offset:17408
    ds_read_b64_tr_b16 v[212:213], v123 offset:16384
    ds_read_b64_tr_b16 v[214:215], v123 offset:17408
    ds_read_b64_tr_b16 v[216:217], v122 offset:18432
    ds_read_b64_tr_b16 v[218:219], v122 offset:19456
    ds_read_b64_tr_b16 v[220:221], v123 offset:18432
    ds_read_b64_tr_b16 v[222:223], v123 offset:19456
    s_waitcnt lgkmcnt(0)
    s_barrier
    s_add_u32 m0, s72, 147456
    s_xor_b32 s68, s87, 229376
    buffer_load_dwordx4 v112, s[52:55], s68 offen offset:0 lds
    buffer_load_dwordx4 v113, s[52:55], s68 offen offset:1024 lds
    s_add_u32 m0, s72, 149504
    s_xor_b32 s68, s87, 237568
    buffer_load_dwordx4 v112, s[52:55], s68 offen offset:0 lds
    buffer_load_dwordx4 v113, s[52:55], s68 offen offset:1024 lds
    s_add_u32 m0, s72, 49152
    s_add_u32 s68, s72, 229376
    buffer_load_dwordx4 v9, s[40:43], s68 offen offset:0 nt lds
    buffer_load_dwordx4 v12, s[40:43], s68 offen offset:1024 nt lds
    buffer_load_dwordx4 v9, s[40:43], s68 offen offset:2048 nt lds
    buffer_load_dwordx4 v12, s[40:43], s68 offen offset:3072 nt lds
    s_add_u32 m0, s72, 65536
    s_add_u32 s68, s72, 245760
    buffer_load_dwordx4 v5, s[36:39], s68 offen offset:0 nt lds
    buffer_load_dwordx4 v6, s[36:39], s68 offen offset:1024 nt lds
    buffer_load_dwordx4 v7, s[36:39], s68 offen offset:2048 nt lds
    buffer_load_dwordx4 v8, s[36:39], s68 offen offset:3072 nt lds
    s_waitcnt vmcnt(20)
    ds_read_b64_tr_b16 v[224:225], v122 offset:0
    ds_read_b64_tr_b16 v[226:227], v122 offset:1024
    ds_read_b64_tr_b16 v[228:229], v123 offset:0
    ds_read_b64_tr_b16 v[230:231], v123 offset:1024
    ds_read_b64_tr_b16 v[232:233], v122 offset:2048
    ds_read_b64_tr_b16 v[234:235], v122 offset:3072
    ds_read_b64_tr_b16 v[236:237], v123 offset:2048
    ds_read_b64_tr_b16 v[238:239], v123 offset:3072
    s_waitcnt lgkmcnt(0)
    s_barrier
    s_add_u32 m0, s72, 81920
    s_add_u32 s68, s72, 245760
    buffer_load_dwordx4 v9, s[40:43], s68 offen offset:0 nt lds
    buffer_load_dwordx4 v12, s[40:43], s68 offen offset:1024 nt lds
    buffer_load_dwordx4 v9, s[40:43], s68 offen offset:2048 nt lds
    buffer_load_dwordx4 v12, s[40:43], s68 offen offset:3072 nt lds
    s_xor_b32 s68, s87, 0
    s_add_u32 m0, s84, 122880
    s_sub_u32 s68, s68, 512
    buffer_load_dwordx4 v112, s[52:55], s68 offen offset:0 lds
    buffer_load_dwordx4 v113, s[52:55], s68 offen offset:1024 lds
    s_xor_b32 s68, s87, 262144
    s_add_u32 m0, s84, 131072
    s_sub_u32 s68, s68, 0
    buffer_load_dwordx4 v112, s[52:55], s68 offen offset:0 lds
    buffer_load_dwordx4 v113, s[52:55], s68 offen offset:1024 lds
    s_waitcnt vmcnt(16)
    ds_read_b64_tr_b16 v[240:241], v122 offset:16384
    ds_read_b64_tr_b16 v[242:243], v122 offset:17408
    ds_read_b64_tr_b16 v[244:245], v123 offset:16384
    ds_read_b64_tr_b16 v[246:247], v123 offset:17408
    ds_read_b64_tr_b16 v[248:249], v122 offset:18432
    ds_read_b64_tr_b16 v[250:251], v122 offset:19456
    ds_read_b64_tr_b16 v[252:253], v123 offset:18432
    ds_read_b64_tr_b16 v[254:255], v123 offset:19456
    s_waitcnt lgkmcnt(0)
    s_barrier
    s_xor_b32 s68, s87, 8192
    s_add_u32 m0, s84, 139264
    s_sub_u32 s68, s68, 512
    buffer_load_dwordx4 v112, s[52:55], s68 offen offset:0 lds
    buffer_load_dwordx4 v113, s[52:55], s68 offen offset:1024 lds
    s_xor_b32 s68, s87, 270336
    s_add_u32 m0, s84, 147456
    s_sub_u32 s68, s68, 0
    buffer_load_dwordx4 v112, s[52:55], s68 offen offset:0 lds
    buffer_load_dwordx4 v113, s[52:55], s68 offen offset:1024 lds
    s_waitcnt vmcnt(12)
    s_barrier
    s_xor_b32 s68, s87, 32768
    s_add_u32 m0, s84, 90112
    s_sub_u32 s68, s68, 512
    buffer_load_dwordx4 v112, s[52:55], s68 offen offset:0 lds
    buffer_load_dwordx4 v113, s[52:55], s68 offen offset:1024 lds
    s_xor_b32 s68, s87, 294912
    s_add_u32 m0, s84, 98304
    s_sub_u32 s68, s68, 0
    buffer_load_dwordx4 v112, s[52:55], s68 offen offset:0 lds
    buffer_load_dwordx4 v113, s[52:55], s68 offen offset:1024 lds
    s_xor_b32 s68, s87, 40960
    s_add_u32 m0, s84, 106496
    s_sub_u32 s68, s68, 512
    buffer_load_dwordx4 v112, s[52:55], s68 offen offset:0 lds
    buffer_load_dwordx4 v113, s[52:55], s68 offen offset:1024 lds
    s_xor_b32 s68, s87, 303104
    s_add_u32 m0, s84, 114688
    s_sub_u32 s68, s68, 0
    buffer_load_dwordx4 v112, s[52:55], s68 offen offset:0 lds
    buffer_load_dwordx4 v113, s[52:55], s68 offen offset:1024 lds
    s_waitcnt vmcnt(16)
L_hmerge:
    s_barrier
    s_waitcnt vmcnt(0)
    ds_read_b64_tr_b16 v[16:17], v118 offset:0
    ds_read_b64_tr_b16 v[18:19], v118 offset:1024
    ds_read_b64_tr_b16 v[20:21], v119 offset:0
    ds_read_b64_tr_b16 v[22:23], v119 offset:1024
    ds_read_b64_tr_b16 v[104:105], v118 offset:16384
    ds_read_b64_tr_b16 v[106:107], v118 offset:17408
    ds_read_b64_tr_b16 v[108:109], v119 offset:16384
    ds_read_b64_tr_b16 v[110:111], v119 offset:17408
    ds_read_b64_tr_b16 v[24:25], v116 offset:32768
    ds_read_b64_tr_b16 v[26:27], v116 offset:33792
    ds_read_b64_tr_b16 v[124:125], v117 offset:32768
    ds_read_b64_tr_b16 v[126:127], v117 offset:33792
    s_waitcnt lgkmcnt(8)
    ds_read_b64_tr_b16 v[8:9], v116 offset:49152
    ds_read_b64_tr_b16 v[10:11], v116 offset:50176
    ds_read_b64_tr_b16 v[12:13], v117 offset:49152
    ds_read_b64_tr_b16 v[14:15], v117 offset:50176
    s_xor_b32 s68, s87, 65536
    s_add_u32 m0, s84, -8192
    s_sub_u32 s68, s68, 512
    buffer_load_dwordx4 v112, s[52:55], s68 offen offset:0 lds
    buffer_load_dwordx4 v113, s[52:55], s68 offen offset:1024 lds
    s_xor_b32 s68, s87, 327680
    s_add_u32 m0, s84, 0
    s_sub_u32 s68, s68, 0
    buffer_load_dwordx4 v112, s[52:55], s68 offen offset:0 lds
    buffer_load_dwordx4 v113, s[52:55], s68 offen offset:1024 lds
    s_xor_b32 s68, s87, 73728
    s_add_u32 m0, s84, 8192
    s_sub_u32 s68, s68, 512
    buffer_load_dwordx4 v112, s[52:55], s68 offen offset:0 lds
    buffer_load_dwordx4 v113, s[52:55], s68 offen offset:1024 lds
    s_xor_b32 s68, s87, 335872
    s_add_u32 m0, s84, 16384
    s_sub_u32 s68, s68, 0
    buffer_load_dwordx4 v112, s[52:55], s68 offen offset:0 lds
    buffer_load_dwordx4 v113, s[52:55], s68 offen offset:1024 lds
    s_xor_b32 s68, s87, 98304
    s_add_u32 m0, s84, 24576
    s_sub_u32 s68, s68, 512
    buffer_load_dwordx4 v112, s[52:55], s68 offen offset:0 lds
    buffer_load_dwordx4 v113, s[52:55], s68 offen offset:1024 lds
    s_xor_b32 s68, s87, 360448
    s_add_u32 m0, s84, 32768
    s_sub_u32 s68, s68, 0
    buffer_load_dwordx4 v112, s[52:55], s68 offen offset:0 lds
    buffer_load_dwordx4 v113, s[52:55], s68 offen offset:1024 lds
    s_waitcnt lgkmcnt(0)
    s_waitcnt vmcnt(0)
    s_barrier
    ds_read_b128 v[48:51], v120 offset:0
    ds_read_b128 v[52:55], v120 offset:1024
    s_add_u32 m0, s84, 131072
    s_xor_b32 s71, s87, 368640
    buffer_load_dwordx4 v112, s[52:55], s71 offen offset:0 lds
    buffer_load_dwordx4 v113, s[52:55], s71 offen offset:1024 lds
    s_add_u32 m0, s84, 147456
    s_xor_b32 s71, s87, 393216
    buffer_load_dwordx4 v112, s[52:55], s71 offen offset:0 lds
    buffer_load_dwordx4 v113, s[52:55], s71 offen offset:1024 lds
    s_add_u32 m0, s84, 98304
    s_xor_b32 s71, s87, 401408
    buffer_load_dwordx4 v112, s[52:55], s71 offen offset:0 lds
    buffer_load_dwordx4 v113, s[52:55], s71 offen offset:1024 lds
    s_add_u32 m0, s84, 114688
    s_xor_b32 s71, s87, 425984
    buffer_load_dwordx4 v112, s[52:55], s71 offen offset:0 lds
    buffer_load_dwordx4 v113, s[52:55], s71 offen offset:1024 lds
    s_add_u32 m0, s84, 81920
    s_xor_b32 s71, s87, 434176
    buffer_load_dwordx4 v112, s[52:55], s71 offen offset:0 lds
    buffer_load_dwordx4 v113, s[52:55], s71 offen offset:1024 lds
    s_setprio 0
    ds_read_b128 v[56:59], v120 offset:2048
    s_waitcnt lgkmcnt(2)
    v_mfma_f32_32x32x16_bf16 v[64:79], v[128:131], v[48:51], 0
    v_mfma_f32_32x32x16_bf16 v[80:95], v[132:135], v[48:51], 0
    ds_read_b128 v[60:63], v120 offset:3072
    s_waitcnt lgkmcnt(2)
    v_mfma_f32_32x32x16_bf16 v[64:79], v[136:139], v[52:55], v[64:79]
    v_mfma_f32_32x32x16_bf16 v[80:95], v[140:143], v[52:55], v[80:95]
    ds_read_b128 v[48:51], v120 offset:4096
    s_waitcnt lgkmcnt(2)
    v_mfma_f32_32x32x16_bf16 v[64:79], v[144:147], v[56:59], v[64:79]
    v_mfma_f32_32x32x16_bf16 v[80:95], v[148:151], v[56:59], v[80:95]
    ds_read_b128 v[52:55], v120 offset:5120
    s_waitcnt lgkmcnt(2)
    v_mfma_f32_32x32x16_bf16 v[64:79], v[152:155], v[60:63], v[64:79]
    v_mfma_f32_32x32x16_bf16 v[80:95], v[156:159], v[60:63], v[80:95]
    ds_read_b128 v[56:59], v120 offset:6144
    s_waitcnt lgkmcnt(2)
    v_mfma_f32_32x32x16_bf16 v[64:79], v[160:163], v[48:51], v[64:79]
    v_mfma_f32_32x32x16_bf16 v[80:95], v[164:167], v[48:51], v[80:95]
    ds_read_b128 v[60:63], v120 offset:7168
    s_waitcnt lgkmcnt(2)
    v_mfma_f32_32x32x16_bf16 v[64:79], v[168:171], v[52:55], v[64:79]
    v_mfma_f32_32x32x16_bf16 v[80:95], v[172:175], v[52:55], v[80:95]
    ds_read_b128 v[48:51], v120 offset:8192
    s_waitcnt lgkmcnt(2)
    v_mfma_f32_32x32x16_bf16 v[64:79], v[176:179], v[56:59], v[64:79]
    v_mfma_f32_32x32x16_bf16 v[80:95], v[180:183], v[56:59], v[80:95]
    ds_read_b128 v[52:55], v120 offset:9216
    s_waitcnt lgkmcnt(2)
    v_mfma_f32_32x32x16_bf16 v[64:79], v[184:187], v[60:63], v[64:79]
    v_mfma_f32_32x32x16_bf16 v[80:95], v[188:191], v[60:63], v[80:95]
    ds_read_b128 v[56:59], v120 offset:10240
    s_waitcnt lgkmcnt(2)
    v_mfma_f32_32x32x16_bf16 v[64:79], v[192:195], v[48:51], v[64:79]
    v_mfma_f32_32x32x16_bf16 v[80:95], v[196:199], v[48:51], v[80:95]
    ds_read_b128 v[60:63], v120 offset:11264
    s_waitcnt lgkmcnt(2)
    v_mfma_f32_32x32x16_bf16 v[64:79], v[200:203], v[52:55], v[64:79]
    v_mfma_f32_32x32x16_bf16 v[80:95], v[204:207], v[52:55], v[80:95]
    ds_read_b128 v[48:51], v120 offset:12288
    s_waitcnt lgkmcnt(2)
    v_mfma_f32_32x32x16_bf16 v[64:79], v[208:211], v[56:59], v[64:79]
    v_mfma_f32_32x32x16_bf16 v[80:95], v[212:215], v[56:59], v[80:95]
    ds_read_b128 v[52:55], v120 offset:13312
    s_waitcnt lgkmcnt(2)
    v_mfma_f32_32x32x16_bf16 v[64:79], v[216:219], v[60:63], v[64:79]
    v_mfma_f32_32x32x16_bf16 v[80:95], v[220:223], v[60:63], v[80:95]
    ds_read_b128 v[56:59], v120 offset:14336
    s_waitcnt lgkmcnt(2)
    v_mfma_f32_32x32x16_bf16 v[64:79], v[224:227], v[48:51], v[64:79]
    v_mfma_f32_32x32x16_bf16 v[80:95], v[228:231], v[48:51], v[80:95]
    ds_read_b128 v[60:63], v120 offset:15360
    s_waitcnt lgkmcnt(2)
    v_mfma_f32_32x32x16_bf16 v[64:79], v[232:235], v[52:55], v[64:79]
    v_mfma_f32_32x32x16_bf16 v[80:95], v[236:239], v[52:55], v[80:95]
    ds_read_b128 v[48:51], v120 offset:16384
    s_waitcnt lgkmcnt(2)
    v_mfma_f32_32x32x16_bf16 v[64:79], v[240:243], v[56:59], v[64:79]
    v_mfma_f32_32x32x16_bf16 v[80:95], v[244:247], v[56:59], v[80:95]
    ds_read_b128 v[52:55], v120 offset:17408
    s_waitcnt lgkmcnt(2)
    v_mfma_f32_32x32x16_bf16 v[64:79], v[248:251], v[60:63], v[64:79]
    v_mfma_f32_32x32x16_bf16 v[80:95], v[252:255], v[60:63], v[80:95]
    ds_read_b128 v[56:59], v120 offset:18432
    s_waitcnt lgkmcnt(2)
    v_mfma_f32_32x32x16_bf16 v[64:79], v[16:19], v[48:51], v[64:79]
    v_mfma_f32_32x32x16_bf16 v[80:95], v[20:23], v[48:51], v[80:95]
    ds_read_b128 v[60:63], v120 offset:19456
    s_waitcnt lgkmcnt(2)
    v_mfma_f32_32x32x16_bf16 v[64:79], v[104:107], v[52:55], v[64:79]
    v_mfma_f32_32x32x16_bf16 v[80:95], v[108:111], v[52:55], v[80:95]
    ds_read_b128 v[48:51], v120 offset:20480
    ds_read_b64_tr_b16 v[96:97], v114 offset:0
    ds_read_b64_tr_b16 v[98:99], v114 offset:1024
    ds_read_b64_tr_b16 v[100:101], v115 offset:0
    ds_read_b64_tr_b16 v[102:103], v115 offset:1024
    s_waitcnt lgkmcnt(6)
    v_mfma_f32_32x32x16_bf16 v[64:79], v[24:27], v[56:59], v[64:79]
    v_mfma_f32_32x32x16_bf16 v[80:95], v[124:127], v[56:59], v[80:95]
    ds_read_b128 v[52:55], v120 offset:21504
    ds_read_b64_tr_b16 v[32:33], v114 offset:16384
    ds_read_b64_tr_b16 v[34:35], v114 offset:17408
    ds_read_b64_tr_b16 v[36:37], v115 offset:16384
    ds_read_b64_tr_b16 v[38:39], v115 offset:17408
    s_waitcnt lgkmcnt(10)
    v_mfma_f32_32x32x16_bf16 v[64:79], v[8:11], v[60:63], v[64:79]
    v_mfma_f32_32x32x16_bf16 v[80:95], v[12:15], v[60:63], v[80:95]
    ds_read_b128 v[56:59], v120 offset:22528
    ds_read_b64_tr_b16 v[40:41], v114 offset:32768
    ds_read_b64_tr_b16 v[42:43], v114 offset:33792
    ds_read_b64_tr_b16 v[44:45], v115 offset:32768
    ds_read_b64_tr_b16 v[46:47], v115 offset:33792
    s_waitcnt lgkmcnt(10)
    v_mfma_f32_32x32x16_bf16 v[64:79], v[96:99], v[48:51], v[64:79]
    v_mfma_f32_32x32x16_bf16 v[80:95], v[100:103], v[48:51], v[80:95]
    s_waitcnt vmcnt(8)
    ds_read_b128 v[60:63], v120 offset:23552
    ds_read_b64_tr_b16 v[96:97], v118 offset:0
    ds_read_b64_tr_b16 v[98:99], v118 offset:1024
    ds_read_b64_tr_b16 v[100:101], v119 offset:0
    ds_read_b64_tr_b16 v[102:103], v119 offset:1024
    s_waitcnt lgkmcnt(10)
    v_mfma_f32_32x32x16_bf16 v[64:79], v[32:35], v[52:55], v[64:79]
    v_mfma_f32_32x32x16_bf16 v[80:95], v[36:39], v[52:55], v[80:95]
    s_waitcnt vmcnt(6)
    ds_read_b128 v[48:51], v120 offset:24576
    ds_read_b64_tr_b16 v[32:33], v118 offset:16384
    ds_read_b64_tr_b16 v[34:35], v118 offset:17408
    ds_read_b64_tr_b16 v[36:37], v119 offset:16384
    ds_read_b64_tr_b16 v[38:39], v119 offset:17408
    s_waitcnt lgkmcnt(10)
    v_mfma_f32_32x32x16_bf16 v[64:79], v[40:43], v[56:59], v[64:79]
    v_mfma_f32_32x32x16_bf16 v[80:95], v[44:47], v[56:59], v[80:95]
    s_waitcnt vmcnt(4)
    ds_read_b128 v[52:55], v120 offset:25600
    ds_read_b64_tr_b16 v[40:41], v116 offset:32768
    ds_read_b64_tr_b16 v[42:43], v116 offset:33792
    ds_read_b64_tr_b16 v[44:45], v117 offset:32768
    ds_read_b64_tr_b16 v[46:47], v117 offset:33792
    s_waitcnt lgkmcnt(10)
    v_mfma_f32_32x32x16_bf16 v[64:79], v[96:99], v[60:63], v[64:79]
    v_mfma_f32_32x32x16_bf16 v[80:95], v[100:103], v[60:63], v[80:95]
    s_waitcnt vmcnt(2)
    ds_read_b128 v[56:59], v120 offset:26624
    ds_read_b64_tr_b16 v[96:97], v116 offset:49152
    ds_read_b64_tr_b16 v[98:99], v116 offset:50176
    ds_read_b64_tr_b16 v[100:101], v117 offset:49152
    ds_read_b64_tr_b16 v[102:103], v117 offset:50176
    s_waitcnt lgkmcnt(10)
    v_mfma_f32_32x32x16_bf16 v[64:79], v[32:35], v[48:51], v[64:79]
    v_mfma_f32_32x32x16_bf16 v[80:95], v[36:39], v[48:51], v[80:95]
    s_add_u32 m0, s84, 0
    s_xor_b32 s71, s87, 458752
    buffer_load_dwordx4 v112, s[52:55], s71 offen offset:0 lds
    buffer_load_dwordx4 v113, s[52:55], s71 offen offset:1024 lds
    s_add_u32 m0, s84, 16384
    s_xor_b32 s71, s87, 466944
    buffer_load_dwordx4 v112, s[52:55], s71 offen offset:0 lds
    buffer_load_dwordx4 v113, s[52:55], s71 offen offset:1024 lds
    s_add_u32 m0, s84, 32768
    s_xor_b32 s71, s87, 491520
    buffer_load_dwordx4 v112, s[52:55], s71 offen offset:0 lds
    buffer_load_dwordx4 v113, s[52:55], s71 offen offset:1024 lds
    s_add_u32 m0, s84, 131072
    s_xor_b32 s71, s87, 499712
    buffer_load_dwordx4 v112, s[52:55], s71 offen offset:0 lds
    buffer_load_dwordx4 v113, s[52:55], s71 offen offset:1024 lds
    s_waitcnt vmcnt(8)
    ds_read_b128 v[60:63], v120 offset:27648
    ds_read_b64_tr_b16 v[32:33], v116 offset:16384
    ds_read_b64_tr_b16 v[34:35], v116 offset:17408
    ds_read_b64_tr_b16 v[36:37], v117 offset:16384
    ds_read_b64_tr_b16 v[38:39], v117 offset:17408
    s_waitcnt lgkmcnt(10)
    v_mfma_f32_32x32x16_bf16 v[64:79], v[40:43], v[52:55], v[64:79]
    v_mfma_f32_32x32x16_bf16 v[80:95], v[44:47], v[52:55], v[80:95]
    s_waitcnt vmcnt(6)
    ds_read_b128 v[48:51], v120 offset:28672
    ds_read_b64_tr_b16 v[40:41], v114 offset:0
    ds_read_b64_tr_b16 v[42:43], v114 offset:1024
    ds_read_b64_tr_b16 v[44:45], v115 offset:0
    ds_read_b64_tr_b16 v[46:47], v115 offset:1024
    s_waitcnt lgkmcnt(10)
    v_mfma_f32_32x32x16_bf16 v[64:79], v[96:99], v[56:59], v[64:79]
    v_mfma_f32_32x32x16_bf16 v[80:95], v[100:103], v[56:59], v[80:95]
    s_waitcnt vmcnt(4)
    ds_read_b128 v[52:55], v120 offset:29696
    ds_read_b64_tr_b16 v[96:97], v114 offset:16384
    ds_read_b64_tr_b16 v[98:99], v114 offset:17408
    ds_read_b64_tr_b16 v[100:101], v115 offset:16384
    ds_read_b64_tr_b16 v[102:103], v115 offset:17408
    s_waitcnt lgkmcnt(10)
    v_mfma_f32_32x32x16_bf16 v[64:79], v[32:35], v[60:63], v[64:79]
    v_mfma_f32_32x32x16_bf16 v[80:95], v[36:39], v[60:63], v[80:95]
    s_waitcnt vmcnt(2)
    ds_read_b128 v[56:59], v120 offset:30720
    ds_read_b64_tr_b16 v[32:33], v114 offset:32768
    ds_read_b64_tr_b16 v[34:35], v114 offset:33792
    ds_read_b64_tr_b16 v[36:37], v115 offset:32768
    ds_read_b64_tr_b16 v[38:39], v115 offset:33792
    s_waitcnt lgkmcnt(10)
    v_mfma_f32_32x32x16_bf16 v[64:79], v[40:43], v[48:51], v[64:79]
    v_mfma_f32_32x32x16_bf16 v[80:95], v[44:47], v[48:51], v[80:95]
    s_waitcnt vmcnt(0)
    ds_read_b128 v[60:63], v120 offset:31744
    ds_read_b64_tr_b16 v[40:41], v118 offset:0
    ds_read_b64_tr_b16 v[42:43], v118 offset:1024
    ds_read_b64_tr_b16 v[44:45], v119 offset:0
    ds_read_b64_tr_b16 v[46:47], v119 offset:1024
    s_waitcnt lgkmcnt(10)
    v_mfma_f32_32x32x16_bf16 v[64:79], v[96:99], v[52:55], v[64:79]
    v_mfma_f32_32x32x16_bf16 v[80:95], v[100:103], v[52:55], v[80:95]
    s_waitcnt lgkmcnt(5)
    v_mfma_f32_32x32x16_bf16 v[64:79], v[32:35], v[56:59], v[64:79]
    v_mfma_f32_32x32x16_bf16 v[80:95], v[36:39], v[56:59], v[80:95]
    s_waitcnt lgkmcnt(0)
    v_mfma_f32_32x32x16_bf16 v[64:79], v[40:43], v[60:63], v[64:79]
    v_mfma_f32_32x32x16_bf16 v[80:95], v[44:47], v[60:63], v[80:95]
L_pub:
    s_lshl_b32 s68, s34, 3
    s_add_u32 s69, s68, s30
    s_lshl_b32 s70, s69, 3
    s_add_u32 s70, s70, s31
    s_lshl_b32 s70, s70, 12
    s_lshl_b32 s69, s69, 7
    s_add_u32 s69, s69, 16777216
    s_lshl_b32 s74, s31, 2
    s_add_u32 s69, s69, s74
    s_add_u32 s68, s68, s31
    v_mov_b32 v10, 1
    v_mov_b32 v11, 0
    v_cvt_pk_bf16_f32 v96, v64, v65
    v_cvt_pk_bf16_f32 v97, v66, v67
    v_cvt_pk_bf16_f32 v98, v68, v69
    v_cvt_pk_bf16_f32 v99, v70, v71
    buffer_store_dwordx4 v[96:99], v4, s[56:59], s70 offen offset:0 sc1
    v_cvt_pk_bf16_f32 v100, v72, v73
    v_cvt_pk_bf16_f32 v101, v74, v75
    v_cvt_pk_bf16_f32 v102, v76, v77
    v_cvt_pk_bf16_f32 v103, v78, v79
    buffer_store_dwordx4 v[100:103], v4, s[56:59], s70 offen offset:1024 sc1
    v_cvt_pk_bf16_f32 v104, v80, v81
    v_cvt_pk_bf16_f32 v105, v82, v83
    v_cvt_pk_bf16_f32 v106, v84, v85
    v_cvt_pk_bf16_f32 v107, v86, v87
    buffer_store_dwordx4 v[104:107], v4, s[56:59], s70 offen offset:2048 sc1
    v_cvt_pk_bf16_f32 v108, v88, v89
    v_cvt_pk_bf16_f32 v109, v90, v91
    v_cvt_pk_bf16_f32 v110, v92, v93
    v_cvt_pk_bf16_f32 v111, v94, v95
    buffer_store_dwordx4 v[108:111], v4, s[56:59], s70 offen offset:3072 sc1
    v_lshlrev_b32 v12, 2, v0
    s_lshl_b32 s75, s68, 7
    s_add_u32 s75, s75, 16777216
    s_lshl_b32 s68, s68, 15
    s_lshr_b32 s74, s30, 1
    s_lshl_b32 s70, s74, 10
    s_add_u32 s68, s68, s70
    s_and_b32 s70, s30, 1
    s_lshl_b32 s71, s70, 8
    s_add_u32 s68, s68, s71
    v_bfe_u32 v14, v0, 4, 1
    v_lshlrev_b32 v15, 4, v2
    v_lshl_add_u32 v15, v14, 9, v15
    v_lshl_add_u32 v15, v3, 12, v15
    v_lshlrev_b32 v20, 11, v2
    v_lshl_add_u32 v20, v14, 4, v20
    v_lshl_add_u32 v20, v3, 3, v20
    s_lshl_b32 s74, s74, 5
    s_lshl_b32 s70, s70, 15
    s_add_u32 s74, s74, s70
    s_waitcnt vmcnt(0)
    s_mov_b64 exec, 1
    buffer_store_dword v10, v11, s[56:59], s69 offen sc1
    s_mov_b64 exec, 0xff
    s_mov_b32 s77, 0
    s_cmp_eq_u32 s30, 0
    s_cbranch_scc0 L_polled
L_poll:
    buffer_load_dword v13, v12, s[56:59], s75 offen sc1
    s_add_u32 s77, s77, 1
    s_cmp_gt_u32 s77, 0x40000
    s_cbranch_scc1 L_polled
    s_waitcnt vmcnt(0)
    v_cmp_ne_u32 vcc, 1, v13
    s_cbranch_vccnz L_poll
L_polled:
    s_mov_b64 exec, -1
    s_barrier
    buffer_load_dwordx4 v[96:99], v15, s[56:59], s68 offen sc1
    s_add_u32 s68, s68, 8192
    buffer_load_dwordx4 v[100:103], v15, s[56:59], s68 offen sc1
    s_add_u32 s68, s68, 8192
    buffer_load_dwordx4 v[104:107], v15, s[56:59], s68 offen sc1
    s_add_u32 s68, s68, 8192
    buffer_load_dwordx4 v[108:111], v15, s[56:59], s68 offen sc1
    s_mov_b32 s69, 0xffff0000
    s_waitcnt vmcnt(3)
    v_lshlrev_b32 v64, 16, v96
    v_and_b32 v65, s69, v96
    v_lshlrev_b32 v66, 16, v97
    v_and_b32 v67, s69, v97
    v_lshlrev_b32 v68, 16, v98
    v_and_b32 v69, s69, v98
    v_lshlrev_b32 v70, 16, v99
    v_and_b32 v71, s69, v99
    s_waitcnt vmcnt(2)
    v_lshlrev_b32 v72, 16, v100
    v_and_b32 v73, s69, v100
    v_lshlrev_b32 v74, 16, v101
    v_and_b32 v75, s69, v101
    v_lshlrev_b32 v76, 16, v102
    v_and_b32 v77, s69, v102
    v_lshlrev_b32 v78, 16, v103
    v_and_b32 v79, s69, v103
    v_add_f32 v64, v64, v72
    v_add_f32 v65, v65, v73
    v_add_f32 v66, v66, v74
    v_add_f32 v67, v67, v75
    v_add_f32 v68, v68, v76
    v_add_f32 v69, v69, v77
    v_add_f32 v70, v70, v78
    v_add_f32 v71, v71, v79
    s_waitcnt vmcnt(1)
    v_lshlrev_b32 v72, 16, v104
    v_and_b32 v73, s69, v104
    v_lshlrev_b32 v74, 16, v105
    v_and_b32 v75, s69, v105
    v_lshlrev_b32 v76, 16, v106
    v_and_b32 v77, s69, v106
    v_lshlrev_b32 v78, 16, v107
    v_and_b32 v79, s69, v107
    v_add_f32 v64, v64, v72
    v_add_f32 v65, v65, v73
    v_add_f32 v66, v66, v74
    v_add_f32 v67, v67, v75
    v_add_f32 v68, v68, v76
    v_add_f32 v69, v69, v77
    v_add_f32 v70, v70, v78
    v_add_f32 v71, v71, v79
    s_waitcnt vmcnt(0)
    v_lshlrev_b32 v72, 16, v108
    v_and_b32 v73, s69, v108
    v_lshlrev_b32 v74, 16, v109
    v_and_b32 v75, s69, v109
    v_lshlrev_b32 v76, 16, v110
    v_and_b32 v77, s69, v110
    v_lshlrev_b32 v78, 16, v111
    v_and_b32 v79, s69, v111
    v_add_f32 v64, v64, v72
    v_add_f32 v65, v65, v73
    v_add_f32 v66, v66, v74
    v_add_f32 v67, v67, v75
    v_add_f32 v68, v68, v76
    v_add_f32 v69, v69, v77
    v_add_f32 v70, v70, v78
    v_add_f32 v71, v71, v79
    s_nop 0
    v_permlane32_swap_b32 v64, v68
    v_permlane32_swap_b32 v65, v69
    v_permlane32_swap_b32 v66, v70
    v_permlane32_swap_b32 v67, v71
    v_add_f32 v64, v64, v68
    v_add_f32 v65, v65, v69
    v_add_f32 v66, v66, v70
    v_add_f32 v67, v67, v71
    v_cvt_pk_bf16_f32 v96, v64, v65
    v_cvt_pk_bf16_f32 v97, v66, v67
    buffer_store_dwordx2 v[96:97], v20, s[60:63], s74 offen
L_end:
    s_endpgm
L_slowA:
    v_max3_f32 v14, v80, v81, v82
    v_max3_f32 v15, v83, v84, v85
    v_max3_f32 v14, v14, v86, v87
    v_max3_f32 v6, v88, v89, v90
    v_max3_f32 v7, v91, v92, v93
    v_max3_f32 v6, v6, v94, v95
    v_max_f32 v14, v14, v15
    v_max_f32 v6, v6, v7
    v_mov_b32 v15, v14
    v_mov_b32 v7, v6
    s_nop 0
    v_permlane32_swap_b32 v14, v15
    v_permlane32_swap_b32 v6, v7
    v_max_f32 v14, v14, v15
    v_max_f32 v6, v6, v7
    v_mov_b32 v15, v14
    v_mov_b32 v7, v6
    s_nop 0
    v_permlane16_swap_b32 v14, v15
    v_permlane16_swap_b32 v6, v7
    v_max3_f32 v14, v14, v15, 0
    v_max3_f32 v6, v6, v7, 0
    v_exp_f32 v15, -v14
    v_exp_f32 v7, -v6
    v_sub_f32 v80, v80, v14
    v_sub_f32 v81, v81, v14
    v_sub_f32 v82, v82, v14
    v_sub_f32 v83, v83, v14
    v_sub_f32 v84, v84, v14
    v_sub_f32 v85, v85, v14
    v_sub_f32 v86, v86, v14
    v_sub_f32 v87, v87, v14
    v_sub_f32 v112, v112, v14
    v_sub_f32 v113, v113, v14
    v_sub_f32 v114, v114, v14
    v_sub_f32 v115, v115, v14
    v_mul_f32 v104, v104, v15
    v_mul_f32 v128, v128, v15
    v_mul_f32 v129, v129, v15
    v_mul_f32 v130, v130, v15
    v_mul_f32 v131, v131, v15
    v_mul_f32 v136, v136, v15
    v_mul_f32 v137, v137, v15
    v_mul_f32 v138, v138, v15
    v_mul_f32 v139, v139, v15
    v_mul_f32 v144, v144, v15
    v_mul_f32 v145, v145, v15
    v_mul_f32 v146, v146, v15
    v_mul_f32 v147, v147, v15
    v_mul_f32 v152, v152, v15
    v_mul_f32 v153, v153, v15
    v_mul_f32 v154, v154, v15
    v_mul_f32 v155, v155, v15
    v_mul_f32 v160, v160, v15
    v_mul_f32 v161, v161, v15
    v_mul_f32 v162, v162, v15
    v_mul_f32 v163, v163, v15
    v_mul_f32 v168, v168, v15
    v_mul_f32 v169, v169, v15
    v_mul_f32 v170, v170, v15
    v_mul_f32 v171, v171, v15
    v_mul_f32 v176, v176, v15
    v_mul_f32 v177, v177, v15
    v_mul_f32 v178, v178, v15
    v_mul_f32 v179, v179, v15
    v_mul_f32 v184, v184, v15
    v_mul_f32 v185, v185, v15
    v_mul_f32 v186, v186, v15
    v_mul_f32 v187, v187, v15
    v_sub_f32 v88, v88, v6
    v_sub_f32 v89, v89, v6
    v_sub_f32 v90, v90, v6
    v_sub_f32 v91, v91, v6
    v_sub_f32 v92, v92, v6
    v_sub_f32 v93, v93, v6
    v_sub_f32 v94, v94, v6
    v_sub_f32 v95, v95, v6
    v_sub_f32 v116, v116, v6
    v_sub_f32 v117, v117, v6
    v_sub_f32 v118, v118, v6
    v_sub_f32 v119, v119, v6
    v_mul_f32 v108, v108, v7
    v_mul_f32 v132, v132, v7
    v_mul_f32 v133, v133, v7
    v_mul_f32 v134, v134, v7
    v_mul_f32 v135, v135, v7
    v_mul_f32 v140, v140, v7
    v_mul_f32 v141, v141, v7
    v_mul_f32 v142, v142, v7
    v_mul_f32 v143, v143, v7
    v_mul_f32 v148, v148, v7
    v_mul_f32 v149, v149, v7
    v_mul_f32 v150, v150, v7
    v_mul_f32 v151, v151, v7
    v_mul_f32 v156, v156, v7
    v_mul_f32 v157, v157, v7
    v_mul_f32 v158, v158, v7
    v_mul_f32 v159, v159, v7
    v_mul_f32 v164, v164, v7
    v_mul_f32 v165, v165, v7
    v_mul_f32 v166, v166, v7
    v_mul_f32 v167, v167, v7
    v_mul_f32 v172, v172, v7
    v_mul_f32 v173, v173, v7
    v_mul_f32 v174, v174, v7
    v_mul_f32 v175, v175, v7
    v_mul_f32 v180, v180, v7
    v_mul_f32 v181, v181, v7
    v_mul_f32 v182, v182, v7
    v_mul_f32 v183, v183, v7
    v_mul_f32 v188, v188, v7
    v_mul_f32 v189, v189, v7
    v_mul_f32 v190, v190, v7
    v_mul_f32 v191, v191, v7
    s_nop 0
    s_branch L_backA
L_slowB:
    v_max3_f32 v14, v64, v65, v66
    v_max3_f32 v15, v67, v68, v69
    v_max3_f32 v14, v14, v70, v71
    v_max3_f32 v6, v72, v73, v74
    v_max3_f32 v7, v75, v76, v77
    v_max3_f32 v6, v6, v78, v79
    v_max_f32 v14, v14, v15
    v_max_f32 v6, v6, v7
    v_mov_b32 v15, v14
    v_mov_b32 v7, v6
    s_nop 0
    v_permlane32_swap_b32 v14, v15
    v_permlane32_swap_b32 v6, v7
    v_max_f32 v14, v14, v15
    v_max_f32 v6, v6, v7
    v_mov_b32 v15, v14
    v_mov_b32 v7, v6
    s_nop 0
    v_permlane16_swap_b32 v14, v15
    v_permlane16_swap_b32 v6, v7
    v_max3_f32 v14, v14, v15, 0
    v_max3_f32 v6, v6, v7, 0
    v_exp_f32 v15, -v14
    v_exp_f32 v7, -v6
    v_sub_f32 v64, v64, v14
    v_sub_f32 v65, v65, v14
    v_sub_f32 v66, v66, v14
    v_sub_f32 v67, v67, v14
    v_sub_f32 v68, v68, v14
    v_sub_f32 v69, v69, v14
    v_sub_f32 v70, v70, v14
    v_sub_f32 v71, v71, v14
    v_sub_f32 v112, v112, v14
    v_sub_f32 v113, v113, v14
    v_sub_f32 v114, v114, v14
    v_sub_f32 v115, v115, v14
    v_mul_f32 v104, v104, v15
    v_mul_f32 v128, v128, v15
    v_mul_f32 v129, v129, v15
    v_mul_f32 v130, v130, v15
    v_mul_f32 v131, v131, v15
    v_mul_f32 v136, v136, v15
    v_mul_f32 v137, v137, v15
    v_mul_f32 v138, v138, v15
    v_mul_f32 v139, v139, v15
    v_mul_f32 v144, v144, v15
    v_mul_f32 v145, v145, v15
    v_mul_f32 v146, v146, v15
    v_mul_f32 v147, v147, v15
    v_mul_f32 v152, v152, v15
    v_mul_f32 v153, v153, v15
    v_mul_f32 v154, v154, v15
    v_mul_f32 v155, v155, v15
    v_mul_f32 v160, v160, v15
    v_mul_f32 v161, v161, v15
    v_mul_f32 v162, v162, v15
    v_mul_f32 v163, v163, v15
    v_mul_f32 v168, v168, v15
    v_mul_f32 v169, v169, v15
    v_mul_f32 v170, v170, v15
    v_mul_f32 v171, v171, v15
    v_mul_f32 v176, v176, v15
    v_mul_f32 v177, v177, v15
    v_mul_f32 v178, v178, v15
    v_mul_f32 v179, v179, v15
    v_mul_f32 v184, v184, v15
    v_mul_f32 v185, v185, v15
    v_mul_f32 v186, v186, v15
    v_mul_f32 v187, v187, v15
    v_sub_f32 v72, v72, v6
    v_sub_f32 v73, v73, v6
    v_sub_f32 v74, v74, v6
    v_sub_f32 v75, v75, v6
    v_sub_f32 v76, v76, v6
    v_sub_f32 v77, v77, v6
    v_sub_f32 v78, v78, v6
    v_sub_f32 v79, v79, v6
    v_sub_f32 v116, v116, v6
    v_sub_f32 v117, v117, v6
    v_sub_f32 v118, v118, v6
    v_sub_f32 v119, v119, v6
    v_mul_f32 v108, v108, v7
    v_mul_f32 v132, v132, v7
    v_mul_f32 v133, v133, v7
    v_mul_f32 v134, v134, v7
    v_mul_f32 v135, v135, v7
    v_mul_f32 v140, v140, v7
    v_mul_f32 v141, v141, v7
    v_mul_f32 v142, v142, v7
    v_mul_f32 v143, v143, v7
    v_mul_f32 v148, v148, v7
    v_mul_f32 v149, v149, v7
    v_mul_f32 v150, v150, v7
    v_mul_f32 v151, v151, v7
    v_mul_f32 v156, v156, v7
    v_mul_f32 v157, v157, v7
    v_mul_f32 v158, v158, v7
    v_mul_f32 v159, v159, v7
    v_mul_f32 v164, v164, v7
    v_mul_f32 v165, v165, v7
    v_mul_f32 v166, v166, v7
    v_mul_f32 v167, v167, v7
    v_mul_f32 v172, v172, v7
    v_mul_f32 v173, v173, v7
    v_mul_f32 v174, v174, v7
    v_mul_f32 v175, v175, v7
    v_mul_f32 v180, v180, v7
    v_mul_f32 v181, v181, v7
    v_mul_f32 v182, v182, v7
    v_mul_f32 v183, v183, v7
    v_mul_f32 v188, v188, v7
    v_mul_f32 v189, v189, v7
    v_mul_f32 v190, v190, v7
    v_mul_f32 v191, v191, v7
    s_nop 0
    s_branch L_backB
L_slowC:
    v_max3_f32 v14, v80, v81, v82
    v_max3_f32 v15, v83, v84, v85
    v_max3_f32 v14, v14, v86, v87
    v_max3_f32 v6, v88, v89, v90
    v_max3_f32 v7, v91, v92, v93
    v_max3_f32 v6, v6, v94, v95
    v_max_f32 v14, v14, v15
    v_max_f32 v6, v6, v7
    v_mov_b32 v15, v14
    v_mov_b32 v7, v6
    s_nop 0
    v_permlane32_swap_b32 v14, v15
    v_permlane32_swap_b32 v6, v7
    v_max_f32 v14, v14, v15
    v_max_f32 v6, v6, v7
    v_mov_b32 v15, v14
    v_mov_b32 v7, v6
    s_nop 0
    v_permlane16_swap_b32 v14, v15
    v_permlane16_swap_b32 v6, v7
    v_max3_f32 v14, v14, v15, 0
    v_max3_f32 v6, v6, v7, 0
    v_exp_f32 v15, -v14
    v_exp_f32 v7, -v6
    v_sub_f32 v80, v80, v14
    v_sub_f32 v81, v81, v14
    v_sub_f32 v82, v82, v14
    v_sub_f32 v83, v83, v14
    v_sub_f32 v84, v84, v14
    v_sub_f32 v85, v85, v14
    v_sub_f32 v86, v86, v14
    v_sub_f32 v87, v87, v14
    v_mul_f32 v104, v104, v15
    v_mul_f32 v128, v128, v15
    v_mul_f32 v129, v129, v15
    v_mul_f32 v130, v130, v15
    v_mul_f32 v131, v131, v15
    v_mul_f32 v136, v136, v15
    v_mul_f32 v137, v137, v15
    v_mul_f32 v138, v138, v15
    v_mul_f32 v139, v139, v15
    v_mul_f32 v144, v144, v15
    v_mul_f32 v145, v145, v15
    v_mul_f32 v146, v146, v15
    v_mul_f32 v147, v147, v15
    v_mul_f32 v152, v152, v15
    v_mul_f32 v153, v153, v15
    v_mul_f32 v154, v154, v15
    v_mul_f32 v155, v155, v15
    v_mul_f32 v160, v160, v15
    v_mul_f32 v161, v161, v15
    v_mul_f32 v162, v162, v15
    v_mul_f32 v163, v163, v15
    v_mul_f32 v168, v168, v15
    v_mul_f32 v169, v169, v15
    v_mul_f32 v170, v170, v15
    v_mul_f32 v171, v171, v15
    v_mul_f32 v176, v176, v15
    v_mul_f32 v177, v177, v15
    v_mul_f32 v178, v178, v15
    v_mul_f32 v179, v179, v15
    v_mul_f32 v184, v184, v15
    v_mul_f32 v185, v185, v15
    v_mul_f32 v186, v186, v15
    v_mul_f32 v187, v187, v15
    v_sub_f32 v88, v88, v6
    v_sub_f32 v89, v89, v6
    v_sub_f32 v90, v90, v6
    v_sub_f32 v91, v91, v6
    v_sub_f32 v92, v92, v6
    v_sub_f32 v93, v93, v6
    v_sub_f32 v94, v94, v6
    v_sub_f32 v95, v95, v6
    v_mul_f32 v108, v108, v7
    v_mul_f32 v132, v132, v7
    v_mul_f32 v133, v133, v7
    v_mul_f32 v134, v134, v7
    v_mul_f32 v135, v135, v7
    v_mul_f32 v140, v140, v7
    v_mul_f32 v141, v141, v7
    v_mul_f32 v142, v142, v7
    v_mul_f32 v143, v143, v7
    v_mul_f32 v148, v148, v7
    v_mul_f32 v149, v149, v7
    v_mul_f32 v150, v150, v7
    v_mul_f32 v151, v151, v7
    v_mul_f32 v156, v156, v7
    v_mul_f32 v157, v157, v7
    v_mul_f32 v158, v158, v7
    v_mul_f32 v159, v159, v7
    v_mul_f32 v164, v164, v7
    v_mul_f32 v165, v165, v7
    v_mul_f32 v166, v166, v7
    v_mul_f32 v167, v167, v7
    v_mul_f32 v172, v172, v7
    v_mul_f32 v173, v173, v7
    v_mul_f32 v174, v174, v7
    v_mul_f32 v175, v175, v7
    v_mul_f32 v180, v180, v7
    v_mul_f32 v181, v181, v7
    v_mul_f32 v182, v182, v7
    v_mul_f32 v183, v183, v7
    v_mul_f32 v188, v188, v7
    v_mul_f32 v189, v189, v7
    v_mul_f32 v190, v190, v7
    v_mul_f32 v191, v191, v7
    s_nop 0
    s_branch L_backC
.section .rodata,"a"
.p2align 6
.amdhsa_kernel concat_heads__gqa_block_cached__gqa_block_cached__near_ridge_kernel
  .amdhsa_next_free_vgpr 256
  .amdhsa_next_free_sgpr 102
  .amdhsa_accum_offset 256
  .amdhsa_group_segment_fixed_size 0
  .amdhsa_kernarg_size 104
  .amdhsa_user_sgpr_count 2
  .amdhsa_user_sgpr_kernarg_segment_ptr 1
  .amdhsa_system_sgpr_workgroup_id_x 1
.end_amdhsa_kernel
```
